```python
import torch

def _softmax(x, axis=-1):
    return torch.softmax(x, dim=axis)
def _gelu(x):
    return torch.nn.functional.gelu(x, approximate="tanh")
def _silu(x):
    return torch.nn.functional.silu(x)
def _sigmoid(x):
    return torch.sigmoid(x)
def _layernorm(x, axis=-1, eps=1e-5):
    m = x.mean(dim=axis, keepdim=True)
    v = x.var(dim=axis, keepdim=True, unbiased=False)
    return (x - m) / torch.sqrt(v + eps)
def _scatter_add(tgt, idx, src, axis=0):
    return tgt.clone().index_add_(axis, idx, src)
def _segment_sum(src, seg, n):
    out = torch.zeros((n,) + src.shape[1:], dtype=src.dtype)
    return out.index_add_(0, seg, src)
def _pad(x, pw):
    flat = tuple(v for pair in reversed(pw) for v in pair)
    return torch.nn.functional.pad(x, flat)

kernel_name = 'sequential_preLN__sliding_block_cached__dense_activation_silu__decode'

def setup_inputs():

    _w = (lambda a: (lambda t: t.to(torch.bfloat16) if t.is_floating_point() else t)(torch.as_tensor(a)))
    def _A_setup():
        B, Sq, D = 1, 1, 640
        Hq, Hkv, Sk, Dh = 32, 32, 4096, 192
        assert Hq % Hkv == 0, (Hq, Hkv)
        return {
            "x": _w((lambda *s: torch.randn(*s, dtype=torch.bfloat16) * 0.05)(B, Sq, D)),
            "k_cache": _w((lambda *s: torch.randn(*s, dtype=torch.bfloat16) * 1.6)(B, Hkv, Sk, Dh)),
            "v_cache": _w((lambda *s: torch.randn(*s, dtype=torch.bfloat16) * 0.4)(B, Hkv, Sk, Dh)),
            "wq": _w((lambda *s: torch.randn(*s, dtype=torch.bfloat16) * 1.6)(D, Hq * Dh) * (D ** -0.5)),
            "wo": _w((lambda *s: torch.randn(*s, dtype=torch.bfloat16) * 0.4)(Hq * Dh, D) * ((Hq * Dh) ** -0.5)),
        }
    _A_in = _A_setup()

    def _B_setup():
        B, S, D, F = 1, 1, 640, 1536
        return {
            "x": _w((lambda *s: torch.randn(*s, dtype=torch.bfloat16) * 0.05)(B, S, D)),
            "w1": _w((lambda *s: torch.randn(*s, dtype=torch.bfloat16) * 0.8)(D, F) * (D ** -0.5)),
            "w2": _w((lambda *s: torch.randn(*s, dtype=torch.bfloat16) * 0.1)(F, D) * (F ** -0.5)),
        }
    _B_in = _B_setup()

    return {
        "A_x": _A_in["x"],
        "A_k_cache": _A_in["k_cache"],
        "A_v_cache": _A_in["v_cache"],
        "A_wq": _A_in["wq"],
        "A_wo": _A_in["wo"],
        "B_x": _B_in["x"],
        "B_w1": _B_in["w1"],
        "B_w2": _B_in["w2"],
    }

def reference(A_x, A_k_cache, A_v_cache, A_wq, A_wo, B_x, B_w1, B_w2):
    def _A_ref(x, k_cache, v_cache, wq, wo):
        B, Sq, D = x.shape
        Hq, Dh = 32, 192
        Hkv, Sk = k_cache.shape[1], k_cache.shape[2]
        W = min(4096, max(256, Sk // 4))
        rep = Hq // Hkv
        q = (lambda x, *d: x.permute(*d))((x @ wq).reshape(B, Sq, Hq, Dh), 0, 2, 1, 3)
        k = (lambda x, n, axis: torch.repeat_interleave(x, n, dim=axis))(k_cache[:, :, Sk - W:, :], rep, axis=1)
        v = (lambda x, n, axis: torch.repeat_interleave(x, n, dim=axis))(v_cache[:, :, Sk - W:, :], rep, axis=1)
        scores = torch.einsum("bhqd,bhkd->bhqk", q, k) * (Dh ** -0.5)
        p = _softmax(scores, axis=-1)
        o = torch.einsum("bhqk,bhkd->bhqd", p, v)
        return (lambda x, *d: x.permute(*d))(o, 0, 2, 1, 3).reshape(B, Sq, Hq * Dh) @ wo

    def _B_ref(x, w1, w2):
        h = torch.einsum("bsd,df->bsf", x, w1)
        h = _silu(h)
        out = torch.einsum("bsf,fd->bsd", h, w2)
        return out

    x = A_x
    h = x + _A_ref(_layernorm(x, axis=-1), A_k_cache, A_v_cache, A_wq, A_wo)
    h2 = h + _B_ref(_layernorm(h, axis=-1), B_w1, B_w2)
    return h2
```

```asm
; @launch grid=(256,1,1) block=(320,1,1) lds=17408
.amdgcn_target "amdgcn-amd-amdhsa--gfx950"
.text
.globl sequential_preLN__sliding_block_cached__dense_activation_silu__decode_kernel
.p2align 12
.fill 192, 4, 0xbf810000
.p2align 8
.type sequential_preLN__sliding_block_cached__dense_activation_silu__decode_kernel,@function
sequential_preLN__sliding_block_cached__dense_activation_silu__decode_kernel:
L_start:

    s_cmp_ge_u32 s2, 256
    s_cbranch_scc1 L_end
    s_load_dwordx16 s[4:19], s[0:1], 0
    s_load_dwordx4 s[20:23], s[0:1], 64
    s_load_dwordx2 s[24:25], s[0:1], 80

    s_getpc_b64 s[40:41]
L_pc:
    v_subrev_u32 v62, 256, v0
    s_lshr_b32 s46, s2, 3
    v_cmp_gt_u32 vcc, 8, v62
    s_lshl_b32 s46, s46, 9
    v_lshl_add_u32 v62, v62, 6, s46
    v_min_u32 v62, L_end-L_pc, v62
    s_and_saveexec_b64 s[42:43], vcc
    s_cbranch_execz L_nopt
    global_load_dword v60, v62, s[40:41]
L_nopt:
    s_mov_b64 exec, -1
    v_lshrrev_b32 v11, 6, v0
    v_and_b32 v1, 63, v0
    v_readfirstlane_b32 s26, v11
    v_lshrrev_b32 v2, 5, v1
    v_and_b32 v3, 31, v1
    s_and_b32 s3, s2, 7
    s_lshr_b32 s66, s2, 3
    s_lshr_b32 s27, s66, 3
    s_lshl_b32 s46, s3, 2
    s_add_u32 s27, s27, s46
    s_and_b32 s28, s66, 7
    s_lshl_b32 s29, s27, 3
    s_add_u32 s29, s29, s28
    s_mov_b32 s31, 1023
    s_mov_b32 s44, 0x05040100
    s_mov_b32 s45, 0x07060302
    s_mov_b32 s64, 0xffff0000
    s_mul_i32 s60, s66, 26
    s_lshr_b32 s60, s60, 8
    s_mul_i32 s46, s60, 10
    s_sub_u32 s61, s66, s46
    s_cmp_eq_u32 s26, 4
    s_cbranch_scc1 L_red

    v_mul_u32_u24 v4, 12, v1
    v_mul_u32_u24 v11, 20, v1
    v_mul_u32_u24 v6, 12, v3
    s_mov_b32 s46, 122880
    v_mad_u32_u24 v6, v2, s46, v6
    v_add_u32 v4, 3840, v4
    v_add_u32 v5, 8448, v4
    s_mul_i32 s46, s28, 983040
    s_mul_i32 s47, s26, 245760
    s_add_u32 s46, s46, s47
    s_mul_i32 s47, s27, 384
    s_add_u32 s46, s46, s47
    s_mul_i32 s47, s27, 1572864
    s_mul_i32 s48, s28, 49152
    s_add_u32 s47, s47, s48
    s_mul_i32 s48, s26, 12288
    s_add_u32 s47, s47, s48
    s_add_u32 s47, s47, 1179648
    s_waitcnt lgkmcnt(0)

    s_load_dword s51, s[24:25], 0
    global_load_dwordx4 v[16:19], v11, s[4:5]
    global_load_dword v20, v11, s[4:5] offset:16
    s_add_u32 s32, s10, s46
    s_addc_u32 s33, s11, 0
    global_load_dwordx3 v[68:70], v6, s[32:33] nt
    s_add_u32 s32, s32, 12288
    s_addc_u32 s33, s33, 0
    global_load_dwordx3 v[72:74], v6, s[32:33] nt
    s_add_u32 s32, s32, 12288
    s_addc_u32 s33, s33, 0
    s_add_u32 s34, s6, s47
    s_addc_u32 s35, s7, 0
    s_add_u32 s36, s8, s47
    s_addc_u32 s37, s9, 0
    global_load_dwordx3 v[76:78], v6, s[32:33] nt
    s_add_u32 s32, s32, 12288
    s_addc_u32 s33, s33, 0
    global_load_dwordx3 v[80:82], v6, s[32:33] nt
    s_add_u32 s32, s32, 12288
    s_addc_u32 s33, s33, 0
    global_load_dwordx3 v[84:86], v6, s[32:33] nt
    s_add_u32 s32, s32, 12288
    s_addc_u32 s33, s33, 0
    global_load_dwordx3 v[88:90], v6, s[32:33] nt
    s_add_u32 s32, s32, 12288
    s_addc_u32 s33, s33, 0
    global_load_dwordx3 v[92:94], v6, s[32:33] nt
    s_add_u32 s32, s32, 12288
    s_addc_u32 s33, s33, 0
    global_load_dwordx3 v[96:98], v6, s[32:33] nt
    s_add_u32 s32, s32, 12288
    s_addc_u32 s33, s33, 0
    global_load_dwordx3 v[100:102], v6, s[32:33] nt
    s_add_u32 s32, s32, 12288
    s_addc_u32 s33, s33, 0
    global_load_dwordx3 v[104:106], v6, s[32:33] nt
    s_mov_b32 s14, s66
    s_lshl_b32 s49, s60, 2
    s_add_u32 s49, s49, s26
    s_min_u32 s49, s49, 11
    s_mul_i32 s46, s3, 12
    s_add_u32 s46, s46, s49
    s_mul_i32 s46, s46, 81920
    s_lshl_b32 s47, s61, 7
    s_add_u32 s46, s46, s47
    s_add_u32 s38, s12, s46
    s_addc_u32 s39, s13, 0
    v_bfe_u32 v8, v1, 4, 1
    v_and_b32 v9, 15, v1
    v_mul_u32_u24 v7, 2560, v2
    v_lshl_add_u32 v7, v9, 3, v7
    v_mov_b32 v15, v7
    s_mov_b32 s46, 40960
    v_mad_u32_u24 v7, v8, s46, v7
    s_cmp_lt_u32 s14, 30
    s_cselect_b32 s46, -1, 0
    v_and_b32 v7, s46, v7
    s_mul_i32 s47, s49, 86
    s_lshr_b32 s47, s47, 8
    s_mul_i32 s48, s47, 3
    s_sub_u32 s49, s49, s48
    s_lshl_b32 s48, s3, 2
    s_add_u32 s47, s47, s48
    s_mul_i32 s46, s47, 8192
    s_add_u32 s46, s46, 327680
    s_add_u32 s52, s24, s46
    s_addc_u32 s53, s25, 0
    s_add_u32 s54, s52, 2097152
    s_addc_u32 s55, s53, 0
    v_lshrrev_b32 v60, 3, v1
    v_and_b32 v61, 7, v1
    v_lshlrev_b32 v66, 8, v60
    v_lshl_add_u32 v66, v61, 4, v66
    s_lshl_b32 s49, s49, 11
    v_add_u32 v66, s49, v66
    v_lshlrev_b32 v67, 4, v60
    v_add_u32 v67, 6144, v67
    v_mul_u32_u24 v13, 24, v3
    v_mad_u32_u24 v13, v2, 12, v13
    s_mul_i32 s46, s26, 768
    v_add_u32 v13, s46, v13
    v_lshlrev_b32 v14, 4, v9
    v_lshl_add_u32 v14, v2, 3, v14
    v_lshl_add_u32 v14, v8, 2, v14
    s_lshl_b32 s46, s26, 8
    s_add_u32 s46, s46, 4096
    v_add_u32 v14, s46, v14
    v_mov_b32 v54, 0
    v_mov_b32 v55, 0
    v_mov_b32 v56, 0
    v_mov_b32 v57, 0
    v_mov_b32 v58, 0
    v_mov_b32 v59, 0
    v_mov_b32 v115, 0
    v_mov_b32 v119, 0
    v_mov_b32 v123, 0
    v_mov_b32 v127, 0
    v_mov_b32 v131, 0
    v_mov_b32 v135, 0
    v_mov_b32 v139, 0
    v_mov_b32 v143, 0
    v_mov_b32 v147, 0
    v_mov_b32 v151, 0
    v_mov_b32 v155, 0
    v_mov_b32 v159, 0
    v_mov_b32 v163, 0
    v_mov_b32 v167, 0
    v_mov_b32 v171, 0
    v_mov_b32 v175, 0
    s_waitcnt vmcnt(10)
    v_lshlrev_b32 v26, 16, v16
    v_and_b32 v27, s64, v16
    v_lshlrev_b32 v28, 16, v17
    v_and_b32 v29, s64, v17
    v_lshlrev_b32 v30, 16, v18
    v_and_b32 v31, s64, v18
    v_lshlrev_b32 v32, 16, v19
    v_and_b32 v33, s64, v19
    v_lshlrev_b32 v34, 16, v20
    v_and_b32 v35, s64, v20
    v_readfirstlane_b32 s46, v26
    s_nop 1
    v_mov_b32 v60, s46
    v_mov_b32 v61, s46
    v_pk_add_f32 v[36:37], v[26:27], v[60:61] neg_lo:[0,1] neg_hi:[0,1]
    v_pk_add_f32 v[38:39], v[28:29], v[60:61] neg_lo:[0,1] neg_hi:[0,1]
    v_pk_add_f32 v[40:41], v[30:31], v[60:61] neg_lo:[0,1] neg_hi:[0,1]
    v_pk_add_f32 v[42:43], v[32:33], v[60:61] neg_lo:[0,1] neg_hi:[0,1]
    v_pk_add_f32 v[44:45], v[34:35], v[60:61] neg_lo:[0,1] neg_hi:[0,1]
    v_pk_add_f32 v[62:63], v[36:37], v[38:39]
    v_pk_mul_f32 v[64:65], v[36:37], v[36:37]
    v_pk_fma_f32 v[64:65], v[38:39], v[38:39], v[64:65]
    v_pk_add_f32 v[62:63], v[62:63], v[40:41]
    v_pk_fma_f32 v[64:65], v[40:41], v[40:41], v[64:65]
    v_pk_add_f32 v[62:63], v[62:63], v[42:43]
    v_pk_fma_f32 v[64:65], v[42:43], v[42:43], v[64:65]
    v_pk_add_f32 v[62:63], v[62:63], v[44:45]
    v_pk_fma_f32 v[64:65], v[44:45], v[44:45], v[64:65]
    v_add_f32 v62, v62, v63
    v_add_f32 v64, v64, v65
    s_nop 0
    v_add_f32_dpp v62, v62, v62 quad_perm:[1,0,3,2] row_mask:0xf bank_mask:0xf
    v_add_f32_dpp v64, v64, v64 quad_perm:[1,0,3,2] row_mask:0xf bank_mask:0xf
    s_nop 0
    v_add_f32_dpp v62, v62, v62 quad_perm:[2,3,0,1] row_mask:0xf bank_mask:0xf
    v_add_f32_dpp v64, v64, v64 quad_perm:[2,3,0,1] row_mask:0xf bank_mask:0xf
    s_nop 0
    v_add_f32_dpp v62, v62, v62 row_half_mirror row_mask:0xf bank_mask:0xf
    v_add_f32_dpp v64, v64, v64 row_half_mirror row_mask:0xf bank_mask:0xf
    s_nop 0
    v_add_f32_dpp v62, v62, v62 row_ror:8 row_mask:0xf bank_mask:0xf
    v_add_f32_dpp v64, v64, v64 row_ror:8 row_mask:0xf bank_mask:0xf
    s_nop 1
    v_permlane16_swap_b32 v62, v64
    v_add_f32 v62, v62, v64
    v_mov_b32 v64, v62
    s_nop 1
    v_permlane32_swap_b32 v62, v64
    v_add_f32 v62, v62, v64
    s_nop 0
    v_readlane_b32 s47, v62, 0
    v_readlane_b32 s48, v62, 16
    v_mov_b32 v63, 0x3acccccd
    v_mul_f32 v62, s47, v63
    v_mul_f32 v64, s48, v63
    v_fma_f32 v64, -v62, v62, v64
    v_add_f32 v62, s46, v62
    v_max_f32 v64, 0, v64
    v_cvt_pk_bf16_f32 v62, v62, v64
    v_and_b32 v64, s64, v62
    v_lshlrev_b32 v60, 16, v62
    v_add_f32 v64, 0x3727c5ac, v64
    v_mov_b32 v61, v60
    v_cvt_pk_bf16_f32 v64, v64, v64
    v_and_b32 v64, s64, v64
    v_sqrt_f32 v64, v64
    v_pk_add_f32 v[36:37], v[26:27], v[60:61] neg_lo:[0,1] neg_hi:[0,1]
    v_pk_add_f32 v[38:39], v[28:29], v[60:61] neg_lo:[0,1] neg_hi:[0,1]
    v_pk_add_f32 v[40:41], v[30:31], v[60:61] neg_lo:[0,1] neg_hi:[0,1]
    v_pk_add_f32 v[42:43], v[32:33], v[60:61] neg_lo:[0,1] neg_hi:[0,1]
    v_pk_add_f32 v[44:45], v[34:35], v[60:61] neg_lo:[0,1] neg_hi:[0,1]
    v_cvt_pk_bf16_f32 v64, v64, v64
    v_and_b32 v64, s64, v64
    v_rcp_f32 v64, v64
    v_cvt_pk_bf16_f32 v16, v36, v37
    v_cvt_pk_bf16_f32 v17, v38, v39
    v_cvt_pk_bf16_f32 v18, v40, v41
    v_cvt_pk_bf16_f32 v19, v42, v43
    v_cvt_pk_bf16_f32 v20, v44, v45
    v_mov_b32 v65, v64
    v_lshlrev_b32 v36, 16, v16
    v_and_b32 v37, s64, v16
    v_lshlrev_b32 v38, 16, v17
    v_and_b32 v39, s64, v17
    v_lshlrev_b32 v40, 16, v18
    v_and_b32 v41, s64, v18
    v_lshlrev_b32 v42, 16, v19
    v_and_b32 v43, s64, v19
    v_lshlrev_b32 v44, 16, v20
    v_and_b32 v45, s64, v20
    v_pk_mul_f32 v[36:37], v[36:37], v[64:65]
    v_pk_mul_f32 v[38:39], v[38:39], v[64:65]
    v_pk_mul_f32 v[40:41], v[40:41], v[64:65]
    v_pk_mul_f32 v[42:43], v[42:43], v[64:65]
    v_pk_mul_f32 v[44:45], v[44:45], v[64:65]
    v_cvt_pk_bf16_f32 v16, v36, v37
    v_cvt_pk_bf16_f32 v17, v38, v39
    v_cvt_pk_bf16_f32 v18, v40, v41
    v_cvt_pk_bf16_f32 v19, v42, v43
    v_cvt_pk_bf16_f32 v20, v44, v45
    s_lshl_b32 s46, s28, 3
    s_lshl_b32 s47, s26, 1
    s_add_u32 s46, s46, s47
    v_add_u32 v11, s46, v2
    v_lshlrev_b32 v11, 2, v11
    ds_bpermute_b32 v46, v11, v16
    ds_bpermute_b32 v47, v11, v17
    ds_bpermute_b32 v48, v11, v18
    ds_bpermute_b32 v49, v11, v19
    ds_bpermute_b32 v50, v11, v20
    s_waitcnt lgkmcnt(0)
    s_add_u32 s30, s51, 1
    s_and_b32 s30, s30, 1023
    v_mov_b32 v10, s30
    v_mov_b32 v11, 3524
    ds_write_b32 v11, v10
    s_cmp_eq_u32 s26, 0
    s_cbranch_scc0 L_noreg
    s_getreg_b32 s47, hwreg(HW_REG_XCC_ID, 0, 4)
    s_lshl_b32 s48, s30, 6
    s_or_b32 s48, s48, s47
    s_or_b32 s48, s48, 0x5a5a0000
    s_mul_i32 s46, s3, 128
    s_add_u32 s46, s46, 32768
    s_add_u32 s40, s24, s46
    s_addc_u32 s41, s25, 0
    s_lshl_b32 s46, s14, 2
    v_mov_b32 v11, s46
    v_mov_b32 v12, s48
    s_mov_b64 exec, 1
    global_store_dword v11, v12, s[40:41]
    s_mov_b64 exec, -1
L_noreg:
    s_waitcnt vmcnt(8)
    global_load_dwordx3 v[112:114], v4, s[34:35] offset:-3840 nt
    v_perm_b32 v60, v72, v68, s44
    v_perm_b32 v61, v72, v68, s45
    v_perm_b32 v62, v73, v69, s44
    v_perm_b32 v63, v73, v69, s45
    v_perm_b32 v64, v74, v70, s44
    v_perm_b32 v65, v74, v70, s45
    v_dot2c_f32_bf16 v54, v60, v46
    v_dot2c_f32_bf16 v55, v61, v46
    v_dot2c_f32_bf16 v56, v62, v46
    v_dot2c_f32_bf16 v57, v63, v46
    v_dot2c_f32_bf16 v58, v64, v46
    v_dot2c_f32_bf16 v59, v65, v46
    s_waitcnt vmcnt(7)
    global_load_dwordx3 v[116:118], v4, s[34:35] offset:-3072 nt
    global_load_dwordx3 v[120:122], v4, s[34:35] offset:-2304 nt
    v_perm_b32 v60, v80, v76, s44
    v_perm_b32 v61, v80, v76, s45
    v_perm_b32 v62, v81, v77, s44
    v_perm_b32 v63, v81, v77, s45
    v_perm_b32 v64, v82, v78, s44
    v_perm_b32 v65, v82, v78, s45
    v_dot2c_f32_bf16 v54, v60, v47
    v_dot2c_f32_bf16 v55, v61, v47
    v_dot2c_f32_bf16 v56, v62, v47
    v_dot2c_f32_bf16 v57, v63, v47
    v_dot2c_f32_bf16 v58, v64, v47
    v_dot2c_f32_bf16 v59, v65, v47
    s_waitcnt vmcnt(7)
    global_load_dwordx3 v[124:126], v4, s[34:35] offset:-1536 nt
    global_load_dwordx3 v[128:130], v4, s[34:35] offset:-768 nt
    v_perm_b32 v60, v88, v84, s44
    v_perm_b32 v61, v88, v84, s45
    v_perm_b32 v62, v89, v85, s44
    v_perm_b32 v63, v89, v85, s45
    v_perm_b32 v64, v90, v86, s44
    v_perm_b32 v65, v90, v86, s45
    v_dot2c_f32_bf16 v54, v60, v48
    v_dot2c_f32_bf16 v55, v61, v48
    v_dot2c_f32_bf16 v56, v62, v48
    v_dot2c_f32_bf16 v57, v63, v48
    v_dot2c_f32_bf16 v58, v64, v48
    v_dot2c_f32_bf16 v59, v65, v48
    s_waitcnt vmcnt(7)
    global_load_dwordx3 v[132:134], v4, s[34:35] offset:0 nt
    global_load_dwordx3 v[136:138], v4, s[34:35] offset:768 nt
    v_perm_b32 v60, v96, v92, s44
    v_perm_b32 v61, v96, v92, s45
    v_perm_b32 v62, v97, v93, s44
    v_perm_b32 v63, v97, v93, s45
    v_perm_b32 v64, v98, v94, s44
    v_perm_b32 v65, v98, v94, s45
    v_dot2c_f32_bf16 v54, v60, v49
    v_dot2c_f32_bf16 v55, v61, v49
    v_dot2c_f32_bf16 v56, v62, v49
    v_dot2c_f32_bf16 v57, v63, v49
    v_dot2c_f32_bf16 v58, v64, v49
    v_dot2c_f32_bf16 v59, v65, v49
    s_waitcnt vmcnt(7)
    global_load_dwordx3 v[140:142], v4, s[34:35] offset:1536 nt
    global_load_dwordx3 v[144:146], v4, s[34:35] offset:2304 nt
    v_perm_b32 v60, v104, v100, s44
    v_perm_b32 v61, v104, v100, s45
    v_perm_b32 v62, v105, v101, s44
    v_perm_b32 v63, v105, v101, s45
    v_perm_b32 v64, v106, v102, s44
    v_perm_b32 v65, v106, v102, s45
    v_dot2c_f32_bf16 v54, v60, v50
    v_dot2c_f32_bf16 v55, v61, v50
    v_dot2c_f32_bf16 v56, v62, v50
    v_dot2c_f32_bf16 v57, v63, v50
    v_dot2c_f32_bf16 v58, v64, v50
    v_dot2c_f32_bf16 v59, v65, v50
    s_nop 0
    v_permlane32_swap_b32 v54, v57
    v_permlane32_swap_b32 v55, v58
    v_permlane32_swap_b32 v56, v59
    v_add_f32 v54, v54, v57
    v_add_f32 v55, v55, v58
    v_add_f32 v56, v56, v59
    ds_write2_b32 v13, v54, v55 offset0:0 offset1:1
    ds_write_b32 v13, v56 offset:8
    s_waitcnt lgkmcnt(0)
    s_barrier
    v_mov_b32 v54, 0
    v_mov_b32 v55, 0
    v_mov_b32 v56, 0
    v_mov_b32 v57, 0
    v_mov_b32 v58, 0
    v_mov_b32 v59, 0
    s_getpc_b64 s[56:57]
L_gp9:
    s_add_u32 s56, s56, L_scores-L_gp9
    s_addc_u32 s57, s57, 0
    s_mov_b32 s65, 0
    v_mov_b32 v12, 3520
    s_waitcnt vmcnt(7)
    global_load_dwordx3 v[148:150], v4, s[34:35] offset:3072 nt
    global_load_dwordx3 v[152:154], v4, s[34:35] offset:3840 nt
    s_waitcnt vmcnt(7)
    global_load_dwordx3 v[156:158], v5, s[34:35] offset:-3840 nt
    global_load_dwordx3 v[160:162], v5, s[34:35] offset:-3072 nt
    s_waitcnt vmcnt(7)
    global_load_dwordx3 v[164:166], v5, s[34:35] offset:-2304 nt
    global_load_dwordx3 v[168:170], v5, s[34:35] offset:-1536 nt
    s_barrier
    s_waitcnt vmcnt(7)
    global_load_dwordx3 v[172:174], v5, s[34:35] offset:-768 nt
    global_load_dwordx3 v[176:178], v4, s[36:37] offset:-3840 nt
    s_waitcnt vmcnt(7)
    global_load_dwordx3 v[180:182], v4, s[36:37] offset:-3072 nt
    global_load_dwordx3 v[184:186], v4, s[36:37] offset:-2304 nt
    s_waitcnt vmcnt(7)
    global_load_dwordx3 v[188:190], v4, s[36:37] offset:-1536 nt
    global_load_dwordx3 v[192:194], v4, s[36:37] offset:-768 nt
    s_waitcnt vmcnt(7)
    global_load_dwordx3 v[196:198], v4, s[36:37] offset:0 nt
    global_load_dwordx3 v[200:202], v4, s[36:37] offset:768 nt
    s_waitcnt vmcnt(7)
    global_load_dwordx3 v[204:206], v4, s[36:37] offset:1536 nt
    global_load_dwordx3 v[208:210], v4, s[36:37] offset:2304 nt
    s_waitcnt vmcnt(7)
    ds_read_b32 v11, v12
    global_load_dwordx3 v[212:214], v4, s[36:37] offset:3072 nt
    global_load_dwordx3 v[216:218], v4, s[36:37] offset:3840 nt
    s_waitcnt lgkmcnt(0)
    v_readfirstlane_b32 s46, v11
    s_nop 0
    s_andn2_b32 s46, s46, s65
    s_cbranch_scc0 Lq_1
    s_swappc_b64 s[58:59], s[56:57]
Lq_1:
    s_waitcnt vmcnt(7)
    ds_read_b32 v11, v12
    global_load_dwordx3 v[220:222], v5, s[36:37] offset:-3840 nt
    global_load_dwordx3 v[224:226], v5, s[36:37] offset:-3072 nt
    s_waitcnt lgkmcnt(0)
    v_readfirstlane_b32 s46, v11
    s_nop 0
    s_andn2_b32 s46, s46, s65
    s_cbranch_scc0 Lq_2
    s_swappc_b64 s[58:59], s[56:57]
Lq_2:
    s_waitcnt vmcnt(7)
    ds_read_b32 v11, v12
    global_load_dwordx3 v[228:230], v5, s[36:37] offset:-2304 nt
    global_load_dwordx3 v[232:234], v5, s[36:37] offset:-1536 nt
    s_waitcnt lgkmcnt(0)
    v_readfirstlane_b32 s46, v11
    s_nop 0
    s_andn2_b32 s46, s46, s65
    s_cbranch_scc0 Lq_3
    s_swappc_b64 s[58:59], s[56:57]
Lq_3:
    s_waitcnt vmcnt(7)
    ds_read_b32 v11, v12
    global_load_dwordx3 v[236:238], v5, s[36:37] offset:-768 nt
    global_load_dwordx2 v[68:69], v7, s[38:39] offset:0 nt
    s_waitcnt lgkmcnt(0)
    v_readfirstlane_b32 s46, v11
    s_nop 0
    s_andn2_b32 s46, s46, s65
    s_cbranch_scc0 Lq_4
    s_swappc_b64 s[58:59], s[56:57]
Lq_4:
    s_waitcnt vmcnt(7)
    ds_read_b32 v11, v12
    global_load_dwordx2 v[70:71], v7, s[38:39] offset:1280 nt
    s_add_u32 s38, s38, 5120
    s_addc_u32 s39, s39, 0
    global_load_dwordx2 v[72:73], v7, s[38:39] offset:0 nt
    global_load_dwordx2 v[74:75], v7, s[38:39] offset:1280 nt
    s_add_u32 s38, s38, 5120
    s_addc_u32 s39, s39, 0
    s_waitcnt lgkmcnt(0)
    v_readfirstlane_b32 s46, v11
    s_nop 0
    s_andn2_b32 s46, s46, s65
    s_cbranch_scc0 Lq_5
    s_swappc_b64 s[58:59], s[56:57]
Lq_5:
    s_cmp_lg_u32 s65, 0
    s_cbranch_scc1 Lq_6_d
    s_mov_b32 s50, 0
Lq_6:
    ds_read_b32 v11, v12
    s_add_u32 s50, s50, 1
    s_cmp_gt_u32 s50, 4000000
    s_cbranch_scc1 L_exit
    s_waitcnt lgkmcnt(0)
    v_readfirstlane_b32 s46, v11
    s_nop 0
    s_cmp_eq_u32 s46, 0
    s_cbranch_scc1 Lq_6
    s_swappc_b64 s[58:59], s[56:57]
Lq_6_d:
    v_perm_b32 v60, v180, v176, s44
    v_perm_b32 v61, v180, v176, s45
    v_perm_b32 v62, v181, v177, s44
    v_perm_b32 v63, v181, v177, s45
    v_perm_b32 v64, v182, v178, s44
    v_perm_b32 v65, v182, v178, s45
    v_dot2c_f32_bf16 v54, v60, v46
    v_dot2c_f32_bf16 v55, v61, v46
    v_dot2c_f32_bf16 v56, v62, v46
    v_dot2c_f32_bf16 v57, v63, v46
    v_dot2c_f32_bf16 v58, v64, v46
    v_dot2c_f32_bf16 v59, v65, v46
    v_perm_b32 v60, v188, v184, s44
    v_perm_b32 v61, v188, v184, s45
    v_perm_b32 v62, v189, v185, s44
    v_perm_b32 v63, v189, v185, s45
    v_perm_b32 v64, v190, v186, s44
    v_perm_b32 v65, v190, v186, s45
    v_dot2c_f32_bf16 v54, v60, v47
    v_dot2c_f32_bf16 v55, v61, v47
    v_dot2c_f32_bf16 v56, v62, v47
    v_dot2c_f32_bf16 v57, v63, v47
    v_dot2c_f32_bf16 v58, v64, v47
    v_dot2c_f32_bf16 v59, v65, v47
    v_perm_b32 v60, v196, v192, s44
    v_perm_b32 v61, v196, v192, s45
    v_perm_b32 v62, v197, v193, s44
    v_perm_b32 v63, v197, v193, s45
    v_perm_b32 v64, v198, v194, s44
    v_perm_b32 v65, v198, v194, s45
    v_dot2c_f32_bf16 v54, v60, v48
    v_dot2c_f32_bf16 v55, v61, v48
    v_dot2c_f32_bf16 v56, v62, v48
    v_dot2c_f32_bf16 v57, v63, v48
    v_dot2c_f32_bf16 v58, v64, v48
    v_dot2c_f32_bf16 v59, v65, v48
    v_perm_b32 v60, v204, v200, s44
    v_perm_b32 v61, v204, v200, s45
    v_perm_b32 v62, v205, v201, s44
    v_perm_b32 v63, v205, v201, s45
    v_perm_b32 v64, v206, v202, s44
    v_perm_b32 v65, v206, v202, s45
    v_dot2c_f32_bf16 v54, v60, v49
    v_dot2c_f32_bf16 v55, v61, v49
    v_dot2c_f32_bf16 v56, v62, v49
    v_dot2c_f32_bf16 v57, v63, v49
    v_dot2c_f32_bf16 v58, v64, v49
    v_dot2c_f32_bf16 v59, v65, v49
    v_perm_b32 v60, v212, v208, s44
    v_perm_b32 v61, v212, v208, s45
    v_perm_b32 v62, v213, v209, s44
    v_perm_b32 v63, v213, v209, s45
    v_perm_b32 v64, v214, v210, s44
    v_perm_b32 v65, v214, v210, s45
    v_dot2c_f32_bf16 v54, v60, v50
    v_dot2c_f32_bf16 v55, v61, v50
    v_dot2c_f32_bf16 v56, v62, v50
    v_dot2c_f32_bf16 v57, v63, v50
    v_dot2c_f32_bf16 v58, v64, v50
    v_dot2c_f32_bf16 v59, v65, v50
    s_waitcnt vmcnt(8)
    global_load_dwordx2 v[76:77], v7, s[38:39] offset:0 nt
    global_load_dwordx2 v[78:79], v7, s[38:39] offset:1280 nt
    s_add_u32 s38, s38, 5120
    s_addc_u32 s39, s39, 0
    global_load_dwordx2 v[80:81], v7, s[38:39] offset:0 nt
    v_perm_b32 v60, v220, v216, s44
    v_perm_b32 v61, v220, v216, s45
    v_perm_b32 v62, v221, v217, s44
    v_perm_b32 v63, v221, v217, s45
    v_perm_b32 v64, v222, v218, s44
    v_perm_b32 v65, v222, v218, s45
    v_dot2c_f32_bf16 v54, v60, v51
    v_dot2c_f32_bf16 v55, v61, v51
    v_dot2c_f32_bf16 v56, v62, v51
    v_dot2c_f32_bf16 v57, v63, v51
    v_dot2c_f32_bf16 v58, v64, v51
    v_dot2c_f32_bf16 v59, v65, v51
    s_waitcnt vmcnt(9)
    global_load_dwordx2 v[82:83], v7, s[38:39] offset:1280 nt
    s_add_u32 s38, s38, 5120
    s_addc_u32 s39, s39, 0
    global_load_dwordx2 v[84:85], v7, s[38:39] offset:0 nt
    global_load_dwordx2 v[86:87], v7, s[38:39] offset:1280 nt
    s_add_u32 s38, s38, 5120
    s_addc_u32 s39, s39, 0
    v_perm_b32 v60, v228, v224, s44
    v_perm_b32 v61, v228, v224, s45
    v_perm_b32 v62, v229, v225, s44
    v_perm_b32 v63, v229, v225, s45
    v_perm_b32 v64, v230, v226, s44
    v_perm_b32 v65, v230, v226, s45
    v_dot2c_f32_bf16 v54, v60, v52
    v_dot2c_f32_bf16 v55, v61, v52
    v_dot2c_f32_bf16 v56, v62, v52
    v_dot2c_f32_bf16 v57, v63, v52
    v_dot2c_f32_bf16 v58, v64, v52
    v_dot2c_f32_bf16 v59, v65, v52
    s_waitcnt vmcnt(10)
    global_load_dwordx2 v[88:89], v7, s[38:39] offset:0 nt
    global_load_dwordx2 v[90:91], v7, s[38:39] offset:1280 nt
    s_add_u32 s38, s38, 5120
    s_addc_u32 s39, s39, 0
    global_load_dwordx2 v[92:93], v7, s[38:39] offset:0 nt
    v_perm_b32 v60, v236, v232, s44
    v_perm_b32 v61, v236, v232, s45
    v_perm_b32 v62, v237, v233, s44
    v_perm_b32 v63, v237, v233, s45
    v_perm_b32 v64, v238, v234, s44
    v_perm_b32 v65, v238, v234, s45
    v_dot2c_f32_bf16 v54, v60, v53
    v_dot2c_f32_bf16 v55, v61, v53
    v_dot2c_f32_bf16 v56, v62, v53
    v_dot2c_f32_bf16 v57, v63, v53
    v_dot2c_f32_bf16 v58, v64, v53
    v_dot2c_f32_bf16 v59, v65, v53
    s_nop 0
    v_permlane32_swap_b32 v54, v57
    v_permlane32_swap_b32 v55, v58
    v_permlane32_swap_b32 v56, v59
    v_add_f32 v54, v54, v57
    v_add_f32 v55, v55, v58
    v_add_f32 v56, v56, v59
    ds_write2_b32 v13, v54, v55 offset0:0 offset1:1
    ds_write_b32 v13, v56 offset:8
    s_waitcnt lgkmcnt(0)
    s_barrier
    s_cmp_lt_u32 s14, 30
    s_cbranch_scc0 L_idle
    v_mov_b32 v54, 0
    v_mov_b32 v55, 0
    v_mov_b32 v56, 0
    v_mov_b32 v57, 0
    s_mov_b32 s50, 0
    s_mul_i32 s46, s3, 192
    s_mul_i32 s47, s26, 48
    s_add_u32 s46, s46, s47
    s_mul_i32 s46, s46, 1280
    s_lshl_b32 s47, s61, 7
    s_add_u32 s46, s46, s47
    s_add_u32 s34, s18, s46
    s_addc_u32 s35, s19, 0
    s_mov_b32 s46, 30720
    v_mad_u32_u24 v9, v8, s46, v15
    s_cmp_lt_u32 s14, 10
    s_cselect_b32 s46, -1, 0
    v_and_b32 v9, s46, v9
    s_lshl_b32 s47, s3, 2
    s_add_u32 s47, s47, s26
    s_mul_i32 s46, s47, 6144
    s_add_u32 s46, s46, 917504
    s_add_u32 s40, s24, s46
    s_addc_u32 s41, s25, 0
    s_add_u32 s42, s40, 2097152
    s_addc_u32 s43, s41, 0
    s_mul_i32 s46, s47, 6144
    s_add_u32 s46, s46, 720896
    s_add_u32 s36, s24, s46
    s_addc_u32 s37, s25, 0
    s_add_u32 s32, s36, 2097152
    s_addc_u32 s33, s37, 0
    s_waitcnt vmcnt(11)
    global_load_dwordx2 v[94:95], v7, s[38:39] offset:1280 nt
    s_add_u32 s38, s38, 5120
    s_addc_u32 s39, s39, 0
    global_load_dwordx2 v[96:97], v7, s[38:39] offset:0 nt
    global_load_dwordx2 v[98:99], v7, s[38:39] offset:1280 nt
    s_add_u32 s38, s38, 5120
    s_addc_u32 s39, s39, 0
    v_perm_b32 v112, v70, v68, s44
    v_perm_b32 v113, v70, v68, s45
    v_perm_b32 v114, v71, v69, s44
    v_perm_b32 v115, v71, v69, s45
    s_waitcnt vmcnt(12)
    v_perm_b32 v116, v74, v72, s44
    v_perm_b32 v117, v74, v72, s45
    v_perm_b32 v118, v75, v73, s44
    v_perm_b32 v119, v75, v73, s45
    s_waitcnt vmcnt(10)
    v_perm_b32 v120, v78, v76, s44
    v_perm_b32 v121, v78, v76, s45
    v_perm_b32 v122, v79, v77, s44
    v_perm_b32 v123, v79, v77, s45
    s_waitcnt vmcnt(8)
    v_perm_b32 v124, v82, v80, s44
    v_perm_b32 v125, v82, v80, s45
    v_perm_b32 v126, v83, v81, s44
    v_perm_b32 v127, v83, v81, s45
    s_waitcnt vmcnt(6)
    v_perm_b32 v128, v86, v84, s44
    v_perm_b32 v129, v86, v84, s45
    v_perm_b32 v130, v87, v85, s44
    v_perm_b32 v131, v87, v85, s45
    s_waitcnt vmcnt(4)
    v_perm_b32 v132, v90, v88, s44
    v_perm_b32 v133, v90, v88, s45
    v_perm_b32 v134, v91, v89, s44
    v_perm_b32 v135, v91, v89, s45
    s_waitcnt vmcnt(2)
    global_load_dwordx4 v[144:147], v66, s[52:53] nt
    global_load_dwordx4 v[148:151], v66, s[52:53] offset:128 nt
    global_load_dwordx4 v[152:155], v67, s[52:53] nt
    v_perm_b32 v136, v94, v92, s44
    v_perm_b32 v137, v94, v92, s45
    v_perm_b32 v138, v95, v93, s44
    v_perm_b32 v139, v95, v93, s45
    s_waitcnt vmcnt(3)
    v_perm_b32 v140, v98, v96, s44
    v_perm_b32 v141, v98, v96, s45
    v_perm_b32 v142, v99, v97, s44
    v_perm_b32 v143, v99, v97, s45
    s_waitcnt vmcnt(2)
    v_xor_b32 v144, v10, v144
    v_xor_b32 v145, v10, v145
    v_xor_b32 v146, v10, v146
    v_xor_b32 v147, v10, v147
    v_or3_b32 v60, v144, v145, v146
    s_waitcnt vmcnt(1)
    v_xor_b32 v148, v10, v148
    v_xor_b32 v149, v10, v149
    v_xor_b32 v150, v10, v150
    v_xor_b32 v151, v10, v151
    v_or3_b32 v60, v60, v147, v148
    v_or3_b32 v60, v60, v149, v150
    s_waitcnt vmcnt(0)
    v_xor_b32 v152, v10, v152
    v_xor_b32 v153, v10, v153
    v_xor_b32 v154, v10, v154
    v_xor_b32 v155, v10, v155
    v_or3_b32 v60, v60, v151, v152
    v_or3_b32 v60, v60, v153, v154
    v_bitop3_b32 v60, v60, v155, s31 bitop3:168
    v_cmp_ne_u32 vcc, 0, v60
    s_cbranch_vccz L_ook
L_opoll:
    s_and_b32 s46, s50, 63
    s_cmp_eq_u32 s46, s67
    s_cselect_b64 s[68:69], s[54:55], s[52:53]
    global_load_dwordx4 v[144:147], v66, s[68:69] nt
    global_load_dwordx4 v[148:151], v66, s[68:69] offset:128 nt
    global_load_dwordx4 v[152:155], v67, s[68:69] nt
    s_add_u32 s50, s50, 1
    s_cmp_gt_u32 s50, 100000
    s_cbranch_scc1 L_exit
    s_waitcnt vmcnt(2)
    v_xor_b32 v144, v10, v144
    v_xor_b32 v145, v10, v145
    v_xor_b32 v146, v10, v146
    v_xor_b32 v147, v10, v147
    v_or3_b32 v60, v144, v145, v146
    s_waitcnt vmcnt(1)
    v_xor_b32 v148, v10, v148
    v_xor_b32 v149, v10, v149
    v_xor_b32 v150, v10, v150
    v_xor_b32 v151, v10, v151
    v_or3_b32 v60, v60, v147, v148
    v_or3_b32 v60, v60, v149, v150
    s_waitcnt vmcnt(0)
    v_xor_b32 v152, v10, v152
    v_xor_b32 v153, v10, v153
    v_xor_b32 v154, v10, v154
    v_xor_b32 v155, v10, v155
    v_or3_b32 v60, v60, v151, v152
    v_or3_b32 v60, v60, v153, v154
    v_bitop3_b32 v60, v60, v155, s31 bitop3:168
    v_cmp_ne_u32 vcc, 0, v60
    s_cbranch_vccnz L_opoll
L_ook:
    s_barrier
    v_max_f32_dpp v60, v152, v152 row_ror:8 row_mask:0xf bank_mask:0xf
    v_mov_b32 v61, v60
    s_nop 1
    v_permlane16_swap_b32 v60, v61
    v_max_f32 v60, v60, v61
    v_mov_b32 v61, v60
    s_nop 1
    v_permlane32_swap_b32 v60, v61
    v_max_f32 v60, v60, v61
    v_sub_f32 v152, v152, v60
    v_mul_f32 v152, 0x3fb8aa3b, v152
    v_exp_f32 v152, v152
    s_nop 0
    v_mul_f32 v153, v152, v153
    v_pk_mul_f32 v[144:145], v[144:145], v[152:153] op_sel_hi:[1,0]
    v_pk_mul_f32 v[146:147], v[146:147], v[152:153] op_sel_hi:[1,0]
    v_pk_mul_f32 v[148:149], v[148:149], v[152:153] op_sel_hi:[1,0]
    v_pk_mul_f32 v[150:151], v[150:151], v[152:153] op_sel_hi:[1,0]
    v_add_f32_dpp v153, v153, v153 row_ror:8 row_mask:0xf bank_mask:0xf
    v_permlane32_swap_b32 v144, v146
    v_permlane32_swap_b32 v145, v147
    v_permlane32_swap_b32 v148, v150
    v_permlane32_swap_b32 v149, v151
    v_mov_b32 v61, v153
    v_add_f32 v144, v144, v146
    v_add_f32 v148, v148, v150
    v_add_f32 v145, v145, v147
    v_add_f32 v149, v149, v151
    v_permlane16_swap_b32 v153, v61
    v_permlane16_swap_b32 v144, v148
    v_permlane16_swap_b32 v145, v149
    v_add_f32 v153, v153, v61
    v_mov_b32 v61, v153
    v_add_f32 v144, v144, v148
    v_add_f32 v145, v145, v149
    v_permlane32_swap_b32 v153, v61
    v_add_f32_dpp v144, v144, v144 row_ror:8 row_mask:0xf bank_mask:0xf
    v_add_f32_dpp v145, v145, v145 row_ror:8 row_mask:0xf bank_mask:0xf
    v_add_f32 v153, v153, v61
    v_rcp_f32 v153, v153
    s_nop 0
    v_mul_f32 v144, v144, v153
    v_mul_f32 v145, v145, v153
    v_cvt_pk_bf16_f32 v144, v144, v145
    s_nop 1
    v_dot2c_f32_bf16_dpp v54, v144, v112 row_newbcast:0 row_mask:0xf bank_mask:0xf
    v_dot2c_f32_bf16_dpp v55, v144, v113 row_newbcast:0 row_mask:0xf bank_mask:0xf
    v_dot2c_f32_bf16_dpp v56, v144, v114 row_newbcast:0 row_mask:0xf bank_mask:0xf
    v_dot2c_f32_bf16_dpp v57, v144, v115 row_newbcast:0 row_mask:0xf bank_mask:0xf
    v_dot2c_f32_bf16_dpp v54, v144, v116 row_newbcast:1 row_mask:0xf bank_mask:0xf
    v_dot2c_f32_bf16_dpp v55, v144, v117 row_newbcast:1 row_mask:0xf bank_mask:0xf
    v_dot2c_f32_bf16_dpp v56, v144, v118 row_newbcast:1 row_mask:0xf bank_mask:0xf
    v_dot2c_f32_bf16_dpp v57, v144, v119 row_newbcast:1 row_mask:0xf bank_mask:0xf
    v_dot2c_f32_bf16_dpp v54, v144, v120 row_newbcast:2 row_mask:0xf bank_mask:0xf
    v_dot2c_f32_bf16_dpp v55, v144, v121 row_newbcast:2 row_mask:0xf bank_mask:0xf
    v_dot2c_f32_bf16_dpp v56, v144, v122 row_newbcast:2 row_mask:0xf bank_mask:0xf
    v_dot2c_f32_bf16_dpp v57, v144, v123 row_newbcast:2 row_mask:0xf bank_mask:0xf
    v_dot2c_f32_bf16_dpp v54, v144, v124 row_newbcast:3 row_mask:0xf bank_mask:0xf
    v_dot2c_f32_bf16_dpp v55, v144, v125 row_newbcast:3 row_mask:0xf bank_mask:0xf
    v_dot2c_f32_bf16_dpp v56, v144, v126 row_newbcast:3 row_mask:0xf bank_mask:0xf
    v_dot2c_f32_bf16_dpp v57, v144, v127 row_newbcast:3 row_mask:0xf bank_mask:0xf
    v_dot2c_f32_bf16_dpp v54, v144, v128 row_newbcast:4 row_mask:0xf bank_mask:0xf
    v_dot2c_f32_bf16_dpp v55, v144, v129 row_newbcast:4 row_mask:0xf bank_mask:0xf
    v_dot2c_f32_bf16_dpp v56, v144, v130 row_newbcast:4 row_mask:0xf bank_mask:0xf
    v_dot2c_f32_bf16_dpp v57, v144, v131 row_newbcast:4 row_mask:0xf bank_mask:0xf
    v_dot2c_f32_bf16_dpp v54, v144, v132 row_newbcast:5 row_mask:0xf bank_mask:0xf
    v_dot2c_f32_bf16_dpp v55, v144, v133 row_newbcast:5 row_mask:0xf bank_mask:0xf
    v_dot2c_f32_bf16_dpp v56, v144, v134 row_newbcast:5 row_mask:0xf bank_mask:0xf
    v_dot2c_f32_bf16_dpp v57, v144, v135 row_newbcast:5 row_mask:0xf bank_mask:0xf
    v_dot2c_f32_bf16_dpp v54, v144, v136 row_newbcast:6 row_mask:0xf bank_mask:0xf
    v_dot2c_f32_bf16_dpp v55, v144, v137 row_newbcast:6 row_mask:0xf bank_mask:0xf
    v_dot2c_f32_bf16_dpp v56, v144, v138 row_newbcast:6 row_mask:0xf bank_mask:0xf
    v_dot2c_f32_bf16_dpp v57, v144, v139 row_newbcast:6 row_mask:0xf bank_mask:0xf
    v_dot2c_f32_bf16_dpp v54, v144, v140 row_newbcast:7 row_mask:0xf bank_mask:0xf
    v_dot2c_f32_bf16_dpp v55, v144, v141 row_newbcast:7 row_mask:0xf bank_mask:0xf
    v_dot2c_f32_bf16_dpp v56, v144, v142 row_newbcast:7 row_mask:0xf bank_mask:0xf
    v_dot2c_f32_bf16_dpp v57, v144, v143 row_newbcast:7 row_mask:0xf bank_mask:0xf
    s_nop 1
    v_permlane32_swap_b32 v54, v56
    v_permlane32_swap_b32 v55, v57
    v_add_f32 v54, v54, v56
    v_add_f32 v55, v55, v57
    s_nop 1
    v_permlane16_swap_b32 v54, v55
    v_add_f32 v54, v54, v55
    ds_write_b32 v14, v54
    s_waitcnt lgkmcnt(0)
    s_barrier
    s_cmp_lt_u32 s14, 10
    s_cbranch_scc0 L_exit
    v_lshlrev_b32 v11, 4, v1
    v_add_u32 v12, 3072, v11
    s_mul_i32 s46, s26, 6144
    s_add_u32 s46, s46, 5120
    v_and_b32 v60, 15, v1
    v_lshlrev_b32 v60, 3, v60
    v_lshl_add_u32 v60, v2, 8, v60
    v_mul_u32_u24 v61, 3072, v8
    v_add3_u32 v4, v60, v61, s46
    s_barrier
    s_cmp_lt_u32 s26, 2
    s_cbranch_scc1 L_w2s
    global_load_dwordx2 v[68:69], v9, s[34:35] offset:0 nt
    global_load_dwordx2 v[70:71], v9, s[34:35] offset:1280 nt
    s_add_u32 s34, s34, 5120
    s_addc_u32 s35, s35, 0
    global_load_dwordx2 v[72:73], v9, s[34:35] offset:0 nt
    global_load_dwordx2 v[74:75], v9, s[34:35] offset:1280 nt
    s_add_u32 s34, s34, 5120
    s_addc_u32 s35, s35, 0
    global_load_dwordx2 v[76:77], v9, s[34:35] offset:0 nt
    global_load_dwordx2 v[78:79], v9, s[34:35] offset:1280 nt
    s_add_u32 s34, s34, 5120
    s_addc_u32 s35, s35, 0
    global_load_dwordx2 v[80:81], v9, s[34:35] offset:0 nt
    global_load_dwordx2 v[82:83], v9, s[34:35] offset:1280 nt
    s_add_u32 s34, s34, 5120
    s_addc_u32 s35, s35, 0
    global_load_dwordx2 v[84:85], v9, s[34:35] offset:0 nt
    global_load_dwordx2 v[86:87], v9, s[34:35] offset:1280 nt
    s_add_u32 s34, s34, 5120
    s_addc_u32 s35, s35, 0
    global_load_dwordx2 v[88:89], v9, s[34:35] offset:0 nt
    global_load_dwordx2 v[90:91], v9, s[34:35] offset:1280 nt
    s_add_u32 s34, s34, 5120
    s_addc_u32 s35, s35, 0
L_w2s:
    v_mov_b32 v54, 0
    v_mov_b32 v55, 0
    v_mov_b32 v56, 0
    v_mov_b32 v57, 0
    v_mov_b32 v144, 0
    v_mov_b32 v176, 0
    v_mov_b32 v145, 0
    v_mov_b32 v177, 0
    v_mov_b32 v146, 0
    v_mov_b32 v178, 0
    v_mov_b32 v147, 0
    v_mov_b32 v179, 0
    v_mov_b32 v148, 0
    v_mov_b32 v180, 0
    v_mov_b32 v149, 0
    v_mov_b32 v181, 0
    v_mov_b32 v150, 0
    v_mov_b32 v182, 0
    v_mov_b32 v151, 0
    v_mov_b32 v183, 0
    v_mov_b32 v152, 0
    v_mov_b32 v184, 0
    v_mov_b32 v153, 0
    v_mov_b32 v185, 0
    v_mov_b32 v154, 0
    v_mov_b32 v186, 0
    v_mov_b32 v155, 0
    v_mov_b32 v187, 0
    v_mov_b32 v156, 0
    v_mov_b32 v188, 0
    v_mov_b32 v157, 0
    v_mov_b32 v189, 0
    v_mov_b32 v158, 0
    v_mov_b32 v190, 0
    v_mov_b32 v159, 0
    v_mov_b32 v191, 0
    v_mov_b32 v160, 0
    v_mov_b32 v192, 0
    v_mov_b32 v161, 0
    v_mov_b32 v193, 0
    v_mov_b32 v162, 0
    v_mov_b32 v194, 0
    v_mov_b32 v163, 0
    v_mov_b32 v195, 0
    v_mov_b32 v164, 0
    v_mov_b32 v196, 0
    v_mov_b32 v165, 0
    v_mov_b32 v197, 0
    v_mov_b32 v166, 0
    v_mov_b32 v198, 0
    v_mov_b32 v167, 0
    v_mov_b32 v199, 0
    v_mov_b32 v18, 0x3acccccd
    s_mov_b32 s56, 0x3f3f3f3f
    s_mov_b32 s57, 0x3f3f3f3f
    s_mov_b32 s58, 0x3f3f3f3f
    s_mov_b32 s59, 0
    s_mov_b32 s50, 0
    s_waitcnt vmcnt(0)
    s_barrier
    s_mov_b64 exec, s[56:57]
    global_load_dwordx4 v[144:147], v11, s[40:41] offset:0 sc1
    global_load_dwordx4 v[148:151], v11, s[40:41] offset:1024 sc1
    global_load_dwordx4 v[156:159], v12, s[40:41] offset:0 sc1
    global_load_dwordx4 v[160:163], v12, s[40:41] offset:1024 sc1
    s_mov_b32 exec_hi, 0
    global_load_dwordx4 v[152:155], v11, s[40:41] offset:2048 sc1
    global_load_dwordx4 v[164:167], v12, s[40:41] offset:2048 sc1
    s_mov_b64 exec, -1
    s_cmp_lt_u32 s26, 2
    s_cbranch_scc0 L_w2r
    ds_read_b64 v[68:69], v4 offset:0
    ds_read_b64 v[70:71], v4 offset:128
    ds_read_b64 v[72:73], v4 offset:512
    ds_read_b64 v[74:75], v4 offset:640
    ds_read_b64 v[76:77], v4 offset:1024
    ds_read_b64 v[78:79], v4 offset:1152
    ds_read_b64 v[80:81], v4 offset:1536
    ds_read_b64 v[82:83], v4 offset:1664
    ds_read_b64 v[84:85], v4 offset:2048
    ds_read_b64 v[86:87], v4 offset:2176
    ds_read_b64 v[88:89], v4 offset:2560
    ds_read_b64 v[90:91], v4 offset:2688
    s_waitcnt lgkmcnt(0)
L_w2r:
    v_perm_b32 v112, v70, v68, s44
    v_perm_b32 v113, v70, v68, s45
    v_perm_b32 v114, v71, v69, s44
    v_perm_b32 v115, v71, v69, s45
    v_perm_b32 v116, v74, v72, s44
    v_perm_b32 v117, v74, v72, s45
    v_perm_b32 v118, v75, v73, s44
    v_perm_b32 v119, v75, v73, s45
    v_perm_b32 v120, v78, v76, s44
    v_perm_b32 v121, v78, v76, s45
    v_perm_b32 v122, v79, v77, s44
    v_perm_b32 v123, v79, v77, s45
    v_perm_b32 v124, v82, v80, s44
    v_perm_b32 v125, v82, v80, s45
    v_perm_b32 v126, v83, v81, s44
    v_perm_b32 v127, v83, v81, s45
    v_perm_b32 v128, v86, v84, s44
    v_perm_b32 v129, v86, v84, s45
    v_perm_b32 v130, v87, v85, s44
    v_perm_b32 v131, v87, v85, s45
    v_perm_b32 v132, v90, v88, s44
    v_perm_b32 v133, v90, v88, s45
    v_perm_b32 v134, v91, v89, s44
    v_perm_b32 v135, v91, v89, s45
    s_mov_b64 exec, s[56:57]
    s_waitcnt vmcnt(5)
    v_xor_b32 v144, v10, v144
    v_xor_b32 v145, v10, v145
    v_xor_b32 v146, v10, v146
    v_xor_b32 v147, v10, v147
    v_or3_b32 v60, v144, v145, v146
    s_waitcnt vmcnt(4)
    v_xor_b32 v148, v10, v148
    v_xor_b32 v149, v10, v149
    v_xor_b32 v150, v10, v150
    v_xor_b32 v151, v10, v151
    v_or3_b32 v60, v60, v147, v148
    v_or3_b32 v60, v60, v149, v150
    s_waitcnt vmcnt(3)
    v_xor_b32 v156, v10, v156
    v_xor_b32 v157, v10, v157
    v_xor_b32 v158, v10, v158
    v_xor_b32 v159, v10, v159
    v_or3_b32 v60, v60, v151, v156
    v_or3_b32 v60, v60, v157, v158
    s_waitcnt vmcnt(2)
    v_xor_b32 v160, v10, v160
    v_xor_b32 v161, v10, v161
    v_xor_b32 v162, v10, v162
    v_xor_b32 v163, v10, v163
    v_or3_b32 v60, v60, v159, v160
    v_or3_b32 v60, v60, v161, v162
    v_bitop3_b32 v60, v60, v163, s31 bitop3:168
    v_cmp_ne_u32 s[62:63], 0, v60
    s_mov_b32 exec_hi, 0
    s_waitcnt vmcnt(1)
    v_xor_b32 v152, v10, v152
    v_xor_b32 v153, v10, v153
    v_xor_b32 v154, v10, v154
    v_xor_b32 v155, v10, v155
    v_or3_b32 v61, v152, v153, v154
    s_waitcnt vmcnt(0)
    v_xor_b32 v164, v10, v164
    v_xor_b32 v165, v10, v165
    v_xor_b32 v166, v10, v166
    v_xor_b32 v167, v10, v167
    v_or3_b32 v61, v61, v155, v164
    v_or3_b32 v61, v61, v165, v166
    v_bitop3_b32 v61, v61, v167, s31 bitop3:168
    v_cmp_ne_u32 vcc, 0, v61
    s_nop 0
    s_or_b64 vcc, vcc, s[62:63]
    s_cbranch_scc0 L_csg_ok
L_csg:
    s_and_b32 s46, s50, 63
    s_cmp_eq_u32 s46, s67
    s_cselect_b64 s[68:69], s[42:43], s[40:41]
    s_mov_b64 exec, s[56:57]
    global_load_dwordx4 v[144:147], v11, s[68:69] offset:0 sc1
    global_load_dwordx4 v[148:151], v11, s[68:69] offset:1024 sc1
    global_load_dwordx4 v[156:159], v12, s[68:69] offset:0 sc1
    global_load_dwordx4 v[160:163], v12, s[68:69] offset:1024 sc1
    s_mov_b32 exec_hi, 0
    global_load_dwordx4 v[152:155], v11, s[68:69] offset:2048 sc1
    global_load_dwordx4 v[164:167], v12, s[68:69] offset:2048 sc1
    s_add_u32 s50, s50, 1
    s_cmp_gt_u32 s50, 100000
    s_cbranch_scc1 L_exit
    s_mov_b64 exec, s[56:57]
    s_waitcnt vmcnt(5)
    v_xor_b32 v144, v10, v144
    v_xor_b32 v145, v10, v145
    v_xor_b32 v146, v10, v146
    v_xor_b32 v147, v10, v147
    v_or3_b32 v60, v144, v145, v146
    s_waitcnt vmcnt(4)
    v_xor_b32 v148, v10, v148
    v_xor_b32 v149, v10, v149
    v_xor_b32 v150, v10, v150
    v_xor_b32 v151, v10, v151
    v_or3_b32 v60, v60, v147, v148
    v_or3_b32 v60, v60, v149, v150
    s_waitcnt vmcnt(3)
    v_xor_b32 v156, v10, v156
    v_xor_b32 v157, v10, v157
    v_xor_b32 v158, v10, v158
    v_xor_b32 v159, v10, v159
    v_or3_b32 v60, v60, v151, v156
    v_or3_b32 v60, v60, v157, v158
    s_waitcnt vmcnt(2)
    v_xor_b32 v160, v10, v160
    v_xor_b32 v161, v10, v161
    v_xor_b32 v162, v10, v162
    v_xor_b32 v163, v10, v163
    v_or3_b32 v60, v60, v159, v160
    v_or3_b32 v60, v60, v161, v162
    v_bitop3_b32 v60, v60, v163, s31 bitop3:168
    v_cmp_ne_u32 s[62:63], 0, v60
    s_mov_b32 exec_hi, 0
    s_waitcnt vmcnt(1)
    v_xor_b32 v152, v10, v152
    v_xor_b32 v153, v10, v153
    v_xor_b32 v154, v10, v154
    v_xor_b32 v155, v10, v155
    v_or3_b32 v61, v152, v153, v154
    s_waitcnt vmcnt(0)
    v_xor_b32 v164, v10, v164
    v_xor_b32 v165, v10, v165
    v_xor_b32 v166, v10, v166
    v_xor_b32 v167, v10, v167
    v_or3_b32 v61, v61, v155, v164
    v_or3_b32 v61, v61, v165, v166
    v_bitop3_b32 v61, v61, v167, s31 bitop3:168
    v_cmp_ne_u32 vcc, 0, v61
    s_nop 0
    s_or_b64 vcc, vcc, s[62:63]
    s_cbranch_scc1 L_csg
L_csg_ok:
    s_mov_b64 exec, -1
    v_pk_add_f32 v[144:145], v[144:145], v[148:149]
    v_pk_add_f32 v[146:147], v[146:147], v[150:151]
    v_pk_add_f32 v[156:157], v[156:157], v[160:161]
    v_pk_add_f32 v[158:159], v[158:159], v[162:163]
    v_pk_add_f32 v[144:145], v[144:145], v[152:153]
    v_pk_add_f32 v[146:147], v[146:147], v[154:155]
    v_pk_add_f32 v[156:157], v[156:157], v[164:165]
    v_pk_add_f32 v[158:159], v[158:159], v[166:167]
    v_permlane32_swap_b32 v144, v146
    v_permlane32_swap_b32 v145, v147
    v_permlane32_swap_b32 v156, v158
    v_permlane32_swap_b32 v157, v159
    v_add_f32 v144, v144, v146
    v_add_f32 v156, v156, v158
    v_add_f32 v145, v145, v147
    v_add_f32 v157, v157, v159
    v_permlane16_swap_b32 v144, v156
    s_nop 0
    v_permlane16_swap_b32 v145, v157
    v_add_f32 v144, v144, v156
    v_add_f32 v145, v145, v157
    s_nop 0
    v_add_f32_dpp v144, v144, v144 row_ror:8 row_mask:0xf bank_mask:0xf
    v_add_f32_dpp v145, v145, v145 row_ror:8 row_mask:0xf bank_mask:0xf
    s_mov_b32 s56, 0x7f7f7f7f
    s_mov_b32 s57, 0x7f7f7f7f
    s_mov_b32 s58, 0x7f7f7f7f
    s_mov_b32 s59, 0
    s_mov_b32 s50, 0
L_ug:
    s_and_b32 s46, s50, 63
    s_cmp_eq_u32 s46, s67
    s_cselect_b64 s[68:69], s[32:33], s[36:37]
    s_mov_b64 exec, s[56:57]
    global_load_dwordx4 v[176:179], v11, s[68:69] offset:0 sc1
    global_load_dwordx4 v[180:183], v11, s[68:69] offset:1024 sc1
    global_load_dwordx4 v[188:191], v12, s[68:69] offset:0 sc1
    global_load_dwordx4 v[192:195], v12, s[68:69] offset:1024 sc1
    s_mov_b32 exec_hi, 0
    global_load_dwordx4 v[184:187], v11, s[68:69] offset:2048 sc1
    global_load_dwordx4 v[196:199], v12, s[68:69] offset:2048 sc1
    s_add_u32 s50, s50, 1
    s_cmp_gt_u32 s50, 100000
    s_cbranch_scc1 L_exit
    s_mov_b64 exec, s[56:57]
    s_waitcnt vmcnt(5)
    v_xor_b32 v176, v10, v176
    v_xor_b32 v177, v10, v177
    v_xor_b32 v178, v10, v178
    v_xor_b32 v179, v10, v179
    v_or3_b32 v60, v176, v177, v178
    s_waitcnt vmcnt(4)
    v_xor_b32 v180, v10, v180
    v_xor_b32 v181, v10, v181
    v_xor_b32 v182, v10, v182
    v_xor_b32 v183, v10, v183
    v_or3_b32 v60, v60, v179, v180
    v_or3_b32 v60, v60, v181, v182
    s_waitcnt vmcnt(3)
    v_xor_b32 v188, v10, v188
    v_xor_b32 v189, v10, v189
    v_xor_b32 v190, v10, v190
    v_xor_b32 v191, v10, v191
    v_or3_b32 v60, v60, v183, v188
    v_or3_b32 v60, v60, v189, v190
    s_waitcnt vmcnt(2)
    v_xor_b32 v192, v10, v192
    v_xor_b32 v193, v10, v193
    v_xor_b32 v194, v10, v194
    v_xor_b32 v195, v10, v195
    v_or3_b32 v60, v60, v191, v192
    v_or3_b32 v60, v60, v193, v194
    v_bitop3_b32 v60, v60, v195, s31 bitop3:168
    v_cmp_ne_u32 s[62:63], 0, v60
    s_mov_b32 exec_hi, 0
    s_waitcnt vmcnt(1)
    v_xor_b32 v184, v10, v184
    v_xor_b32 v185, v10, v185
    v_xor_b32 v186, v10, v186
    v_xor_b32 v187, v10, v187
    v_or3_b32 v61, v184, v185, v186
    s_waitcnt vmcnt(0)
    v_xor_b32 v196, v10, v196
    v_xor_b32 v197, v10, v197
    v_xor_b32 v198, v10, v198
    v_xor_b32 v199, v10, v199
    v_or3_b32 v61, v61, v187, v196
    v_or3_b32 v61, v61, v197, v198
    v_bitop3_b32 v61, v61, v199, s31 bitop3:168
    v_cmp_ne_u32 vcc, 0, v61
    s_nop 0
    s_or_b64 vcc, vcc, s[62:63]
    s_cbranch_scc1 L_ug
L_ug_ok:
    s_mov_b64 exec, -1
    v_pk_add_f32 v[176:177], v[176:177], v[180:181]
    v_pk_add_f32 v[178:179], v[178:179], v[182:183]
    v_pk_add_f32 v[188:189], v[188:189], v[192:193]
    v_pk_add_f32 v[190:191], v[190:191], v[194:195]
    v_pk_add_f32 v[176:177], v[176:177], v[184:185]
    v_pk_add_f32 v[178:179], v[178:179], v[186:187]
    v_pk_add_f32 v[188:189], v[188:189], v[196:197]
    v_pk_add_f32 v[190:191], v[190:191], v[198:199]
    v_permlane32_swap_b32 v176, v178
    v_permlane32_swap_b32 v177, v179
    v_permlane32_swap_b32 v188, v190
    v_permlane32_swap_b32 v189, v191
    v_add_f32 v176, v176, v178
    v_add_f32 v188, v188, v190
    v_add_f32 v177, v177, v179
    v_add_f32 v189, v189, v191
    v_permlane16_swap_b32 v176, v188
    s_nop 0
    v_permlane16_swap_b32 v177, v189
    v_add_f32 v176, v176, v188
    v_add_f32 v177, v177, v189
    s_nop 0
    v_add_f32_dpp v176, v176, v176 row_ror:8 row_mask:0xf bank_mask:0xf
    v_add_f32_dpp v177, v177, v177 row_ror:8 row_mask:0xf bank_mask:0xf
    v_add_f32 v60, v176, v177
    s_nop 0
    v_readlane_b32 s47, v60, 6
    v_readlane_b32 s48, v60, 38
    s_nop 0
    v_mul_f32 v62, s47, v18
    v_mul_f32 v64, s48, v18
    v_fma_f32 v64, -v62, v62, v64
    v_cvt_pk_bf16_f32 v62, v62, v62
    v_max_f32 v64, 0, v64
    v_and_b32 v62, s64, v62
    v_add_f32 v64, 0x3727c5ac, v64
    v_rsq_f32 v64, v64
    v_fma_f32 v176, -v62, v144, v176
    v_fma_f32 v177, -v62, v145, v177
    v_mul_f32 v176, v176, v64
    v_mul_f32 v177, v177, v64
    v_cvt_pk_bf16_f32 v178, v176, v177
    v_lshlrev_b32 v176, 16, v178
    v_and_b32 v177, s64, v178
    v_mul_f32 v60, 0xbfb8aa3b, v176
    v_mul_f32 v61, 0xbfb8aa3b, v177
    v_exp_f32 v60, v60
    v_exp_f32 v61, v61
    v_add_f32 v60, 1.0, v60
    v_add_f32 v61, 1.0, v61
    v_rcp_f32 v60, v60
    v_rcp_f32 v61, v61
    v_mul_f32 v176, v176, v60
    v_mul_f32 v177, v177, v61
    v_cvt_pk_bf16_f32 v176, v176, v177
    s_nop 1
    v_dot2c_f32_bf16_dpp v54, v176, v112 row_newbcast:0 row_mask:0xf bank_mask:0xf
    v_dot2c_f32_bf16_dpp v55, v176, v113 row_newbcast:0 row_mask:0xf bank_mask:0xf
    v_dot2c_f32_bf16_dpp v56, v176, v114 row_newbcast:0 row_mask:0xf bank_mask:0xf
    v_dot2c_f32_bf16_dpp v57, v176, v115 row_newbcast:0 row_mask:0xf bank_mask:0xf
    v_dot2c_f32_bf16_dpp v54, v176, v116 row_newbcast:1 row_mask:0xf bank_mask:0xf
    v_dot2c_f32_bf16_dpp v55, v176, v117 row_newbcast:1 row_mask:0xf bank_mask:0xf
    v_dot2c_f32_bf16_dpp v56, v176, v118 row_newbcast:1 row_mask:0xf bank_mask:0xf
    v_dot2c_f32_bf16_dpp v57, v176, v119 row_newbcast:1 row_mask:0xf bank_mask:0xf
    v_dot2c_f32_bf16_dpp v54, v176, v120 row_newbcast:2 row_mask:0xf bank_mask:0xf
    v_dot2c_f32_bf16_dpp v55, v176, v121 row_newbcast:2 row_mask:0xf bank_mask:0xf
    v_dot2c_f32_bf16_dpp v56, v176, v122 row_newbcast:2 row_mask:0xf bank_mask:0xf
    v_dot2c_f32_bf16_dpp v57, v176, v123 row_newbcast:2 row_mask:0xf bank_mask:0xf
    v_dot2c_f32_bf16_dpp v54, v176, v124 row_newbcast:3 row_mask:0xf bank_mask:0xf
    v_dot2c_f32_bf16_dpp v55, v176, v125 row_newbcast:3 row_mask:0xf bank_mask:0xf
    v_dot2c_f32_bf16_dpp v56, v176, v126 row_newbcast:3 row_mask:0xf bank_mask:0xf
    v_dot2c_f32_bf16_dpp v57, v176, v127 row_newbcast:3 row_mask:0xf bank_mask:0xf
    v_dot2c_f32_bf16_dpp v54, v176, v128 row_newbcast:4 row_mask:0xf bank_mask:0xf
    v_dot2c_f32_bf16_dpp v55, v176, v129 row_newbcast:4 row_mask:0xf bank_mask:0xf
    v_dot2c_f32_bf16_dpp v56, v176, v130 row_newbcast:4 row_mask:0xf bank_mask:0xf
    v_dot2c_f32_bf16_dpp v57, v176, v131 row_newbcast:4 row_mask:0xf bank_mask:0xf
    v_dot2c_f32_bf16_dpp v54, v176, v132 row_newbcast:5 row_mask:0xf bank_mask:0xf
    v_dot2c_f32_bf16_dpp v55, v176, v133 row_newbcast:5 row_mask:0xf bank_mask:0xf
    v_dot2c_f32_bf16_dpp v56, v176, v134 row_newbcast:5 row_mask:0xf bank_mask:0xf
    v_dot2c_f32_bf16_dpp v57, v176, v135 row_newbcast:5 row_mask:0xf bank_mask:0xf
    s_nop 1
    v_permlane32_swap_b32 v54, v56
    v_permlane32_swap_b32 v55, v57
    v_add_f32 v54, v54, v56
    v_add_f32 v55, v55, v57
    s_nop 1
    v_permlane16_swap_b32 v54, v55
    v_add_f32 v54, v54, v55
    ds_write_b32 v14, v54
    s_waitcnt lgkmcnt(0)
    s_barrier
    s_branch L_exit
L_idle:
    s_lshl_b32 s47, s3, 1
    s_add_u32 s47, s47, s61
    s_lshl_b32 s47, s47, 2
    s_add_u32 s47, s47, s26
    s_mul_i32 s46, s47, 3072
    s_add_u32 s46, s46, 720896
    s_add_u32 s40, s24, s46
    s_addc_u32 s41, s25, 0
    s_mul_i32 s46, s47, 3072
    s_add_u32 s46, s46, 917504
    s_add_u32 s42, s24, s46
    s_addc_u32 s43, s25, 0
    v_lshlrev_b32 v60, 6, v1
    s_mov_b32 exec_hi, 0xff
    global_load_dword v61, v60, s[40:41] sc1
    global_load_dword v62, v60, s[42:43] sc1
    s_waitcnt vmcnt(0)
    s_branch L_exit
L_scores:
    v_mul_u32_u24 v11, 12, v3
    v_add_u32 v11, 3072, v11
    ds_read2_b32 v[46:47], v11 offset0:0 offset1:1
    ds_read_b32 v48, v11 offset:8
    s_waitcnt lgkmcnt(0)
    s_bitcmp1_b32 s46, 1
    s_cselect_b32 s67, 63, -1
    v_dot2c_f32_bf16 v115, v112, v46
    v_dot2c_f32_bf16 v119, v116, v46
    v_dot2c_f32_bf16 v123, v120, v46
    v_dot2c_f32_bf16 v127, v124, v46
    v_dot2c_f32_bf16 v131, v128, v46
    v_dot2c_f32_bf16 v135, v132, v46
    v_dot2c_f32_bf16 v139, v136, v46
    v_dot2c_f32_bf16 v143, v140, v46
    v_dot2c_f32_bf16 v147, v144, v46
    v_dot2c_f32_bf16 v151, v148, v46
    v_dot2c_f32_bf16 v155, v152, v46
    v_dot2c_f32_bf16 v159, v156, v46
    v_dot2c_f32_bf16 v163, v160, v46
    v_dot2c_f32_bf16 v167, v164, v46
    v_dot2c_f32_bf16 v171, v168, v46
    v_dot2c_f32_bf16 v175, v172, v46
    v_dot2c_f32_bf16 v115, v113, v47
    v_dot2c_f32_bf16 v119, v117, v47
    v_dot2c_f32_bf16 v123, v121, v47
    v_dot2c_f32_bf16 v127, v125, v47
    v_dot2c_f32_bf16 v131, v129, v47
    v_dot2c_f32_bf16 v135, v133, v47
    v_dot2c_f32_bf16 v139, v137, v47
    v_dot2c_f32_bf16 v143, v141, v47
    v_dot2c_f32_bf16 v147, v145, v47
    v_dot2c_f32_bf16 v151, v149, v47
    v_dot2c_f32_bf16 v155, v153, v47
    v_dot2c_f32_bf16 v159, v157, v47
    v_dot2c_f32_bf16 v163, v161, v47
    v_dot2c_f32_bf16 v167, v165, v47
    v_dot2c_f32_bf16 v171, v169, v47
    v_dot2c_f32_bf16 v175, v173, v47
    v_dot2c_f32_bf16 v115, v114, v48
    v_dot2c_f32_bf16 v119, v118, v48
    v_dot2c_f32_bf16 v123, v122, v48
    v_dot2c_f32_bf16 v127, v126, v48
    v_dot2c_f32_bf16 v131, v130, v48
    v_dot2c_f32_bf16 v135, v134, v48
    v_dot2c_f32_bf16 v139, v138, v48
    v_dot2c_f32_bf16 v143, v142, v48
    v_dot2c_f32_bf16 v147, v146, v48
    v_dot2c_f32_bf16 v151, v150, v48
    v_dot2c_f32_bf16 v155, v154, v48
    v_dot2c_f32_bf16 v159, v158, v48
    v_dot2c_f32_bf16 v163, v162, v48
    v_dot2c_f32_bf16 v167, v166, v48
    v_dot2c_f32_bf16 v171, v170, v48
    v_dot2c_f32_bf16 v175, v174, v48
    v_permlane16_swap_b32 v115, v147
    v_permlane16_swap_b32 v119, v151
    v_permlane16_swap_b32 v123, v155
    v_permlane16_swap_b32 v127, v159
    v_permlane16_swap_b32 v131, v163
    v_permlane16_swap_b32 v135, v167
    v_permlane16_swap_b32 v139, v171
    v_permlane16_swap_b32 v143, v175
    v_add_f32 v115, v115, v147
    v_add_f32 v119, v119, v151
    v_add_f32 v123, v123, v155
    v_add_f32 v127, v127, v159
    v_add_f32 v131, v131, v163
    v_add_f32 v135, v135, v167
    v_add_f32 v139, v139, v171
    v_add_f32 v143, v143, v175
    v_add_f32_dpp v115, v115, v115 row_ror:8 row_mask:0xf bank_mask:0x3
    v_add_f32_dpp v119, v119, v119 row_ror:8 row_mask:0xf bank_mask:0x3
    v_add_f32_dpp v123, v123, v123 row_ror:8 row_mask:0xf bank_mask:0x3
    v_add_f32_dpp v127, v127, v127 row_ror:8 row_mask:0xf bank_mask:0x3
    v_add_f32_dpp v115, v131, v131 row_ror:8 row_mask:0xf bank_mask:0xc
    v_add_f32_dpp v119, v135, v135 row_ror:8 row_mask:0xf bank_mask:0xc
    v_add_f32_dpp v123, v139, v139 row_ror:8 row_mask:0xf bank_mask:0xc
    v_add_f32_dpp v127, v143, v143 row_ror:8 row_mask:0xf bank_mask:0xc
    v_add_f32_dpp v115, v115, v115 row_shl:4 row_mask:0xf bank_mask:0x5
    v_add_f32_dpp v119, v119, v119 row_shl:4 row_mask:0xf bank_mask:0x5
    s_nop 0
    v_add_f32_dpp v115, v123, v123 row_shr:4 row_mask:0xf bank_mask:0xa
    v_add_f32_dpp v119, v127, v127 row_shr:4 row_mask:0xf bank_mask:0xa
    s_nop 0
    v_add_f32_dpp v115, v115, v115 quad_perm:[1,0,3,2] row_mask:0xf bank_mask:0xf
    v_add_f32_dpp v119, v119, v119 quad_perm:[1,0,3,2] row_mask:0xf bank_mask:0xf
    s_nop 0
    v_add_f32_dpp v115, v115, v115 quad_perm:[2,3,0,1] row_mask:0xf bank_mask:0xf
    v_add_f32_dpp v119, v119, v119 quad_perm:[2,3,0,1] row_mask:0xf bank_mask:0xf
    v_cvt_pk_bf16_f32 v62, v115, v119
    v_lshlrev_b32 v60, 16, v62
    v_and_b32 v61, s64, v62
    v_mul_f32 v60, 0x3d93cd3a, v60
    v_mul_f32 v61, 0x3d93cd3a, v61
    v_cvt_pk_bf16_f32 v62, v60, v61
    v_lshlrev_b32 v60, 16, v62
    v_and_b32 v61, s64, v62
    v_max_f32 v64, v60, v61
    s_nop 1
    v_max_f32_dpp v64, v64, v64 row_half_mirror row_mask:0xf bank_mask:0xf
    s_nop 1
    v_max_f32_dpp v64, v64, v64 row_ror:8 row_mask:0xf bank_mask:0xf
    v_mov_b32 v62, v64
    s_nop 1
    v_permlane16_swap_b32 v64, v62
    v_max_f32 v64, v64, v62
    v_mov_b32 v62, v64
    s_nop 1
    v_permlane32_swap_b32 v64, v62
    v_max_f32 v64, v64, v62
    v_sub_f32 v60, v60, v64
    v_sub_f32 v61, v61, v64
    v_mul_f32 v60, 0x3fb8aa3b, v60
    v_mul_f32 v61, 0x3fb8aa3b, v61
    v_exp_f32 v60, v60
    v_exp_f32 v61, v61
    v_and_b32 v11, 60, v1
    s_lshl_b32 s46, s26, 6
    s_add_u32 s46, s46, 3584
    v_cvt_pk_bf16_f32 v62, v60, v61
    v_add_f32 v65, v60, v61
    v_add_u32 v11, s46, v11
    ds_write_b32 v11, v62
    v_lshlrev_b32 v11, 5, v2
    v_add_u32 v11, s46, v11
    ds_read_b128 v[46:49], v11
    ds_read_b128 v[50:53], v11 offset:16
    v_add_f32_dpp v65, v65, v65 row_half_mirror row_mask:0xf bank_mask:0xf
    s_nop 1
    v_add_f32_dpp v65, v65, v65 row_ror:8 row_mask:0xf bank_mask:0xf
    v_mov_b32 v63, v65
    s_nop 1
    v_permlane16_swap_b32 v65, v63
    v_add_f32 v65, v65, v63
    v_mov_b32 v63, v65
    s_nop 1
    v_permlane32_swap_b32 v65, v63
    v_add_f32 v65, v65, v63
    s_lshl_b32 s46, s26, 4
    s_add_u32 s46, s46, 3456
    v_mov_b32 v11, s46
    v_mov_b32 v62, 1
    ds_write_b64 v11, v[64:65]
    ds_write_b32 v11, v62 offset:8
    s_mov_b32 s65, -1
    s_waitcnt lgkmcnt(0)
    s_setpc_b64 s[58:59]
L_red:
    s_setprio 2
    v_lshlrev_b32 v11, 4, v1
    v_add_u32 v12, 3072, v11
    s_mov_b32 s56, -1
    s_mov_b32 s57, 0xffff
    v_lshlrev_b32 v64, 2, v1
    v_mov_b32 v65, 0
    s_mov_b32 exec_lo, 0x1ffff
    s_mov_b32 exec_hi, 0
    ds_write_b32 v64, v65 offset:3456
    s_mov_b64 exec, -1
    s_lshl_b32 s47, s3, 7
    s_add_u32 s47, s47, s66
    s_lshl_b32 s47, s47, 7
    s_add_u32 s47, s47, 1179648
    s_mov_b32 s62, 0
    s_waitcnt lgkmcnt(0)
    s_cmp_lt_u32 s66, 24
    s_cbranch_scc1 L_norace
    s_add_u32 s32, s24, s47
    s_addc_u32 s33, s25, 0
    s_mov_b32 s62, 0
    s_load_dword s49, s[32:33], 8192 glc
    s_load_dword s48, s[32:33], 0 glc
    s_waitcnt lgkmcnt(1)
    s_getreg_b32 s62, hwreg(HW_REG_IB_STS, 8, 4)
    s_waitcnt lgkmcnt(0)
    s_min_u32 s62, s62, 1
L_norace:
    s_mov_b32 s14, s66
    s_mov_b32 s67, 1
    s_max_u32 s15, s14, 10
    s_min_u32 s15, s15, 29
    s_sub_u32 s15, s15, 10
    s_mul_i32 s46, s29, 768
    s_add_u32 s46, s46, 65536
    s_add_u32 s40, s24, s46
    s_addc_u32 s41, s25, 0
    s_add_u32 s42, s40, 2097152
    s_addc_u32 s43, s41, 0
    v_lshrrev_b32 v62, 3, v1
    v_and_b32 v63, 0x70, v11
    v_bfe_u32 v64, v1, 4, 1
    v_lshl_add_u32 v26, v62, 14, v63
    v_lshl_add_u32 v30, v2, 3, v63
    v_lshl_add_u32 v30, v64, 2, v30
    v_lshrrev_b32 v65, 1, v30
    s_lshl_b32 s46, s15, 6
    v_add_u32 v65, s46, v65
    global_load_ushort v15, v65, s[4:5]
    v_mul_u32_u24 v32, 6144, v2
    v_mad_u32_u24 v32, v3, 12, v32
    v_lshrrev_b32 v35, 2, v3
    v_mul_u32_u24 v35, 3072, v35
    v_and_b32 v65, 3, v3
    v_mad_u32_u24 v35, v65, 24, v35
    v_mad_u32_u24 v35, v2, 12, v35
    v_and_b32 v65, 7, v1
    v_mul_u32_u24 v36, 3072, v65
    v_lshl_add_u32 v36, v2, 3, v36
    v_add_u32 v36, 96, v36
    v_lshrrev_b32 v34, 4, v1
    v_lshlrev_b32 v34, 11, v34
    v_and_b32 v65, 0xf0, v11
    v_add_u32 v34, v34, v65
    s_lshl_b32 s46, s28, 8
    s_lshl_b32 s47, s28, 4
    v_mov_b32 v65, s47
    s_mov_b64 exec, s[56:57]
    v_mov_b32 v65, s46
    s_mov_b64 exec, -1
    v_add_u32 v34, v34, v65
    v_and_b32 v38, 0xf0, v11
    v_lshl_add_u32 v33, v64, 13, v38
    v_lshl_add_u32 v33, v2, 17, v33
    s_mul_i32 s46, s27, 6144
    s_add_u32 s46, s46, 65536
    s_add_u32 s52, s24, s46
    s_addc_u32 s53, s25, 0
    s_add_u32 s54, s52, 2097152
    s_addc_u32 s55, s53, 0
    s_mul_i32 s46, s3, 128
    s_add_u32 s46, s46, 32768
    s_add_u32 s34, s24, s46
    s_addc_u32 s35, s25, 0
    s_lshl_b32 s46, s14, 2
    v_mov_b32 v20, s46
    v_lshlrev_b32 v19, 2, v3
    v_mov_b32 v13, 3524
    s_mov_b32 s50, 0
    s_waitcnt lgkmcnt(0)
    s_barrier
    ds_read_b32 v10, v13
    s_mov_b64 exec, s[56:57]
    ds_read_b128 v[112:115], v11 offset:0
    ds_read_b128 v[116:119], v11 offset:768
    ds_read_b128 v[120:123], v11 offset:1536
    ds_read_b128 v[124:127], v11 offset:2304
    s_waitcnt lgkmcnt(0)
    v_pk_add_f32 v[112:113], v[112:113], v[116:117]
    v_pk_add_f32 v[114:115], v[114:115], v[118:119]
    v_pk_add_f32 v[112:113], v[112:113], v[120:121]
    v_pk_add_f32 v[114:115], v[114:115], v[122:123]
    v_pk_add_f32 v[112:113], v[112:113], v[124:125]
    v_pk_add_f32 v[114:115], v[114:115], v[126:127]
    v_bfi_b32 v112, s31, v10, v112
    v_bfi_b32 v113, s31, v10, v113
    v_bfi_b32 v114, s31, v10, v114
    v_bfi_b32 v115, s31, v10, v115
    global_store_dwordx4 v11, v[112:115], s[40:41]
    v_mov_b32 v46, v112
    v_mov_b32 v47, v113
    v_mov_b32 v48, v114
    v_mov_b32 v49, v115
    s_mov_b32 s58, -1
    v_readfirstlane_b32 s30, v10
    s_getreg_b32 s47, hwreg(HW_REG_XCC_ID, 0, 4)
    s_lshl_b32 s66, s30, 6
    s_or_b32 s66, s66, 0x5a5a0000
    s_lshl_b32 s48, s62, 4
    s_or_b32 s48, s48, s66
    v_mov_b32 v63, s48
    s_cmp_lt_u32 s14, 24
    s_cbranch_scc1 L_novote
    s_mov_b64 exec, 1
    global_store_dword v20, v63, s[34:35] offset:1024
    s_mov_b64 exec, s[56:57]
L_novote:
    s_or_b32 s49, s66, s47
    s_or_b32 s66, s66, 16
    s_barrier
L_qpoll:
    s_and_b32 s46, s50, 63
    s_cmp_eq_u32 s46, s58
    s_cselect_b64 s[68:69], s[54:55], s[52:53]
    global_load_dword v18, v19, s[34:35] nt
    global_load_dwordx4 v[112:115], v11, s[68:69] offset:0 nt
    global_load_dwordx4 v[116:119], v11, s[68:69] offset:768 nt
    global_load_dwordx4 v[120:123], v11, s[68:69] offset:1536 nt
    global_load_dwordx4 v[124:127], v11, s[68:69] offset:2304 nt
    global_load_dwordx4 v[128:131], v12, s[68:69] offset:0 nt
    global_load_dwordx4 v[132:135], v12, s[68:69] offset:768 nt
    global_load_dwordx4 v[136:139], v12, s[68:69] offset:1536 nt
    global_load_dwordx4 v[140:143], v12, s[68:69] offset:2304 nt
    s_add_u32 s50, s50, 1
    s_cmp_gt_u32 s50, 100000
    s_cbranch_scc1 L_exit
    s_waitcnt vmcnt(0)
    v_cmp_ne_u32 vcc, s49, v18
    s_nop 0
    s_cmp_lg_u32 vcc_lo, 0
    s_cselect_b32 s58, 63, -1
    s_cselect_b32 s46, s50, 0
    s_cmp_eq_u32 s46, 1
    s_cbranch_scc0 L_nqfb
    global_store_dwordx4 v11, v[46:49], s[42:43] sc1
L_nqfb:
    v_bitop3_b32 v60, v112, v113, v10 bitop3:126
    v_bitop3_b32 v61, v114, v115, v10 bitop3:126
    v_bitop3_b32 v62, v116, v117, v10 bitop3:126
    v_or3_b32 v60, v60, v61, v62
    v_bitop3_b32 v61, v118, v119, v10 bitop3:126
    v_bitop3_b32 v62, v120, v121, v10 bitop3:126
    v_or3_b32 v60, v60, v61, v62
    v_bitop3_b32 v61, v122, v123, v10 bitop3:126
    v_bitop3_b32 v62, v124, v125, v10 bitop3:126
    v_or3_b32 v60, v60, v61, v62
    v_bitop3_b32 v61, v126, v127, v10 bitop3:126
    v_bitop3_b32 v62, v128, v129, v10 bitop3:126
    v_or3_b32 v60, v60, v61, v62
    v_bitop3_b32 v61, v130, v131, v10 bitop3:126
    v_bitop3_b32 v62, v132, v133, v10 bitop3:126
    v_or3_b32 v60, v60, v61, v62
    v_bitop3_b32 v61, v134, v135, v10 bitop3:126
    v_bitop3_b32 v62, v136, v137, v10 bitop3:126
    v_or3_b32 v60, v60, v61, v62
    v_bitop3_b32 v61, v138, v139, v10 bitop3:126
    v_bitop3_b32 v62, v140, v141, v10 bitop3:126
    v_or3_b32 v60, v60, v61, v62
    v_bitop3_b32 v62, v142, v143, v10 bitop3:126
    v_or_b32 v60, v60, v62
    v_and_b32 v60, s31, v60
    v_cmp_ne_u32 vcc, 0, v60
    s_cbranch_vccnz L_qpoll
L_qok:
    v_mov_b32 v60, 512
    v_bfi_b32 v112, s31, v60, v112
    v_bfi_b32 v113, s31, v60, v113
    v_bfi_b32 v114, s31, v60, v114
    v_bfi_b32 v115, s31, v60, v115
    v_bfi_b32 v116, s31, v60, v116
    v_bfi_b32 v117, s31, v60, v117
    v_bfi_b32 v118, s31, v60, v118
    v_bfi_b32 v119, s31, v60, v119
    v_bfi_b32 v120, s31, v60, v120
    v_bfi_b32 v121, s31, v60, v121
    v_bfi_b32 v122, s31, v60, v122
    v_bfi_b32 v123, s31, v60, v123
    v_bfi_b32 v124, s31, v60, v124
    v_bfi_b32 v125, s31, v60, v125
    v_bfi_b32 v126, s31, v60, v126
    v_bfi_b32 v127, s31, v60, v127
    v_bfi_b32 v128, s31, v60, v128
    v_bfi_b32 v129, s31, v60, v129
    v_bfi_b32 v130, s31, v60, v130
    v_bfi_b32 v131, s31, v60, v131
    v_bfi_b32 v132, s31, v60, v132
    v_bfi_b32 v133, s31, v60, v133
    v_bfi_b32 v134, s31, v60, v134
    v_bfi_b32 v135, s31, v60, v135
    v_bfi_b32 v136, s31, v60, v136
    v_bfi_b32 v137, s31, v60, v137
    v_bfi_b32 v138, s31, v60, v138
    v_bfi_b32 v139, s31, v60, v139
    v_bfi_b32 v140, s31, v60, v140
    v_bfi_b32 v141, s31, v60, v141
    v_bfi_b32 v142, s31, v60, v142
    v_bfi_b32 v143, s31, v60, v143
    v_pk_add_f32 v[112:113], v[112:113], v[116:117]
    v_pk_add_f32 v[114:115], v[114:115], v[118:119]
    v_pk_add_f32 v[112:113], v[112:113], v[120:121]
    v_pk_add_f32 v[114:115], v[114:115], v[122:123]
    v_pk_add_f32 v[112:113], v[112:113], v[124:125]
    v_pk_add_f32 v[114:115], v[114:115], v[126:127]
    v_pk_add_f32 v[112:113], v[112:113], v[128:129]
    v_pk_add_f32 v[114:115], v[114:115], v[130:131]
    v_pk_add_f32 v[112:113], v[112:113], v[132:133]
    v_pk_add_f32 v[114:115], v[114:115], v[134:135]
    v_pk_add_f32 v[112:113], v[112:113], v[136:137]
    v_pk_add_f32 v[114:115], v[114:115], v[138:139]
    v_pk_add_f32 v[112:113], v[112:113], v[140:141]
    v_pk_add_f32 v[114:115], v[114:115], v[142:143]
    v_cvt_pk_bf16_f32 v112, v112, v113
    v_cvt_pk_bf16_f32 v113, v114, v115
    v_lshlrev_b32 v12, 3, v1
    ds_write_b64 v12, v[112:113] offset:3072
    v_cmp_ne_u32 vcc, s49, v18
    s_nop 0
    s_cmp_lg_u32 vcc_lo, 0
    s_cselect_b32 s67, 1, 0
    s_lshl1_add_u32 s46, s67, 1
    v_mov_b32 v12, 3520
    v_mov_b32 v60, s46
    ds_write_b32 v12, v60
    s_mov_b64 exec, -1
    global_load_dword v18, v19, s[34:35] offset:1024 nt
    v_lshlrev_b32 v15, 16, v15
    s_mul_i32 s46, s27, 8192
    s_add_u32 s46, s46, 327680
    s_add_u32 s40, s24, s46
    s_addc_u32 s41, s25, 0
    s_add_u32 s42, s40, 2097152
    s_addc_u32 s43, s41, 0
    s_mov_b32 exec_lo, 0x11111111
    s_mov_b32 exec_hi, 0x11111
    global_load_dword v16, v34, s[40:41] sc1
    s_mov_b64 exec, -1
    v_mov_b32 v13, 3456
    s_lshl_b32 s47, s3, 6
    s_mul_i32 s48, s60, 10
    s_add_u32 s47, s47, s48
    s_add_u32 s47, s47, s61
    s_mul_i32 s46, s47, 256
    s_add_u32 s46, s46, 1179648
    s_add_u32 s52, s24, s46
    s_addc_u32 s53, s25, 0
    s_mul_i32 s46, s15, 98304
    s_mul_i32 s47, s3, 384
    s_add_u32 s46, s46, s47
    s_add_u32 s32, s16, s46
    s_addc_u32 s33, s17, 0
    s_mov_b32 s50, 0
L_st:
    ds_read_b96 v[112:114], v13 offset:0
    ds_read_b96 v[116:118], v13 offset:16
    ds_read_b96 v[120:122], v13 offset:32
    ds_read_b96 v[124:126], v13 offset:48
    s_add_u32 s50, s50, 1
    s_cmp_gt_u32 s50, 4000000
    s_cbranch_scc1 L_exit
    s_waitcnt lgkmcnt(0)
    v_and_b32 v60, v114, v118
    v_bitop3_b32 v60, v60, v122, v126 bitop3:0x80
    v_cmp_eq_u32 vcc, 0, v60
    s_cbranch_vccnz L_st
    v_max3_f32 v46, v112, v116, v120
    v_max_f32 v46, v46, v124
    v_sub_f32 v100, v112, v46
    v_sub_f32 v102, v116, v46
    v_sub_f32 v104, v120, v46
    v_sub_f32 v106, v124, v46
    v_mul_f32 v100, 0x3fb8aa3b, v100
    v_mul_f32 v102, 0x3fb8aa3b, v102
    v_mul_f32 v104, 0x3fb8aa3b, v104
    v_mul_f32 v106, 0x3fb8aa3b, v106
    v_exp_f32 v100, v100
    v_exp_f32 v102, v102
    v_exp_f32 v104, v104
    v_exp_f32 v106, v106
    v_mul_f32 v47, v100, v113
    v_fmac_f32 v47, v102, v117
    v_fmac_f32 v47, v104, v121
    v_fmac_f32 v47, v106, v125
    v_mov_b32 v101, v100
    v_mov_b32 v103, v102
    v_mov_b32 v105, v104
    v_mov_b32 v107, v106
    v_or_b32 v46, v46, v10
    v_mov_b32 v48, v10
    v_mov_b32 v49, v10
    v_bfi_b32 v47, s31, v10, v47
    s_mov_b64 exec, s[56:57]
    s_barrier
    ds_read_b128 v[112:115], v11 offset:0
    ds_read_b128 v[116:119], v11 offset:768
    ds_read_b128 v[120:123], v11 offset:1536
    ds_read_b128 v[124:127], v11 offset:2304
    s_waitcnt lgkmcnt(3)
    v_pk_mul_f32 v[112:113], v[112:113], v[100:101]
    v_pk_mul_f32 v[114:115], v[114:115], v[100:101]
    s_waitcnt lgkmcnt(2)
    v_pk_fma_f32 v[112:113], v[116:117], v[102:103], v[112:113]
    v_pk_fma_f32 v[114:115], v[118:119], v[102:103], v[114:115]
    s_waitcnt lgkmcnt(1)
    v_pk_fma_f32 v[112:113], v[120:121], v[104:105], v[112:113]
    v_pk_fma_f32 v[114:115], v[122:123], v[104:105], v[114:115]
    s_waitcnt lgkmcnt(0)
    v_pk_fma_f32 v[112:113], v[124:125], v[106:107], v[112:113]
    v_pk_fma_f32 v[114:115], v[126:127], v[106:107], v[114:115]
    v_bfi_b32 v46, s31, v10, v112
    v_bfi_b32 v47, s31, v10, v113
    v_bfi_b32 v48, s31, v10, v114
    v_bfi_b32 v49, s31, v10, v115
    s_mov_b32 exec_hi, 0x1ffff
    global_store_dwordx4 v34, v[46:49], s[40:41]
    s_cmp_eq_u32 s67, 0
    s_cbranch_scc1 Lfb_7
    global_store_dwordx4 v34, v[46:49], s[42:43] sc1
Lfb_7:
    s_mov_b64 exec, -1
    s_waitcnt vmcnt(1)
    v_cmp_eq_u32 vcc, s66, v18
    s_nop 0
    s_bcnt1_i32_b32 s47, vcc_lo
    s_cmp_gt_u32 s47, 3
    s_cselect_b32 s6, 8192, 0
    s_cmp_lt_u32 s14, 30
    s_cbranch_scc0 L_exit
    s_mul_i32 s46, s3, 245760
    s_lshl_b32 s47, s61, 7
    s_add_u32 s46, s46, s47
    s_add_u32 s36, s18, s46
    s_addc_u32 s37, s19, 0
    v_lshrrev_b32 v39, 3, v1
    v_mul_u32_u24 v39, 1280, v39
    v_and_b32 v60, 0x70, v11
    v_add_u32 v39, v60, v39
    s_mul_i32 s46, s15, 128
    s_add_u32 s46, s46, 1182208
    s_add_u32 s34, s24, s46
    s_addc_u32 s35, s25, 0
    s_mov_b32 s65, s6
    s_add_u32 s34, s34, s65
    s_addc_u32 s35, s35, 0
    s_mul_i32 s46, s15, 128
    s_add_u32 s46, s46, 1441792
    s_add_u32 s54, s24, s46
    s_addc_u32 s55, s25, 0
    s_add_u32 s54, s54, s6
    s_addc_u32 s55, s55, 0
    s_barrier
    s_cmp_lt_u32 s14, 10
    s_cbranch_scc1 L_w2pf
    global_load_dwordx3 v[112:114], v32, s[32:33] nt
    global_load_dwordx3 v[116:118], v32, s[32:33] offset:3072 nt
    s_add_u32 s32, s32, 12288
    s_addc_u32 s33, s33, 0
    global_load_dwordx3 v[120:122], v32, s[32:33] nt
    global_load_dwordx3 v[124:126], v32, s[32:33] offset:3072 nt
    s_add_u32 s32, s32, 12288
    s_addc_u32 s33, s33, 0
    global_load_dwordx3 v[128:130], v32, s[32:33] nt
    global_load_dwordx3 v[132:134], v32, s[32:33] offset:3072 nt
    s_add_u32 s32, s32, 12288
    s_addc_u32 s33, s33, 0
    global_load_dwordx3 v[136:138], v32, s[32:33] nt
    global_load_dwordx3 v[140:142], v32, s[32:33] offset:3072 nt
    s_add_u32 s32, s32, 12288
    s_addc_u32 s33, s33, 0
    global_load_dwordx3 v[144:146], v32, s[32:33] nt
    global_load_dwordx3 v[148:150], v32, s[32:33] offset:3072 nt
    s_add_u32 s32, s32, 12288
    s_addc_u32 s33, s33, 0
    global_load_dwordx3 v[152:154], v32, s[32:33] nt
    global_load_dwordx3 v[156:158], v32, s[32:33] offset:3072 nt
    s_add_u32 s32, s32, 12288
    s_addc_u32 s33, s33, 0
    global_load_dwordx3 v[160:162], v32, s[32:33] nt
    global_load_dwordx3 v[164:166], v32, s[32:33] offset:3072 nt
    s_add_u32 s32, s32, 12288
    s_addc_u32 s33, s33, 0
    global_load_dwordx3 v[168:170], v32, s[32:33] nt
    global_load_dwordx3 v[172:174], v32, s[32:33] offset:3072 nt
    s_branch L_nw1
L_w2pf:
    s_mov_b32 m0, 5120
    s_nop 0
    global_load_lds_dwordx4 v39, s[36:37] nt
    s_add_u32 s36, s36, 10240
    s_addc_u32 s37, s37, 0
    s_mov_b32 m0, 6144
    s_nop 0
    global_load_lds_dwordx4 v39, s[36:37] nt
    s_add_u32 s36, s36, 10240
    s_addc_u32 s37, s37, 0
    s_mov_b32 m0, 7168
    s_nop 0
    global_load_lds_dwordx4 v39, s[36:37] nt
    s_add_u32 s36, s36, 10240
    s_addc_u32 s37, s37, 0
    s_mov_b32 m0, 8192
    s_nop 0
    global_load_lds_dwordx4 v39, s[36:37] nt
    s_add_u32 s36, s36, 10240
    s_addc_u32 s37, s37, 0
    s_mov_b32 m0, 9216
    s_nop 0
    global_load_lds_dwordx4 v39, s[36:37] nt
    s_add_u32 s36, s36, 10240
    s_addc_u32 s37, s37, 0
    s_mov_b32 m0, 10240
    s_nop 0
    global_load_lds_dwordx4 v39, s[36:37] nt
    s_add_u32 s36, s36, 10240
    s_addc_u32 s37, s37, 0
    s_mov_b32 m0, 11264
    s_nop 0
    global_load_lds_dwordx4 v39, s[36:37] nt
    s_add_u32 s36, s36, 10240
    s_addc_u32 s37, s37, 0
    s_mov_b32 m0, 12288
    s_nop 0
    global_load_lds_dwordx4 v39, s[36:37] nt
    s_add_u32 s36, s36, 10240
    s_addc_u32 s37, s37, 0
    s_mov_b32 m0, 13312
    s_nop 0
    global_load_lds_dwordx4 v39, s[36:37] nt
    s_add_u32 s36, s36, 10240
    s_addc_u32 s37, s37, 0
    s_mov_b32 m0, 14336
    s_nop 0
    global_load_lds_dwordx4 v39, s[36:37] nt
    s_add_u32 s36, s36, 10240
    s_addc_u32 s37, s37, 0
    s_mov_b32 m0, 15360
    s_nop 0
    global_load_lds_dwordx4 v39, s[36:37] nt
    s_add_u32 s36, s36, 10240
    s_addc_u32 s37, s37, 0
    s_mov_b32 m0, 16384
    s_nop 0
    global_load_lds_dwordx4 v39, s[36:37] nt
L_nw1:
    s_barrier
    s_mov_b32 exec_hi, 0
    ds_read_b128 v[92:95], v38 offset:4096
    ds_read_b128 v[96:99], v38 offset:4352
    ds_read_b128 v[100:103], v38 offset:4608
    ds_read_b128 v[104:107], v38 offset:4864
    s_waitcnt lgkmcnt(2)
    v_pk_add_f32 v[92:93], v[92:93], v[96:97]
    v_pk_add_f32 v[94:95], v[94:95], v[98:99]
    s_waitcnt lgkmcnt(0)
    v_pk_add_f32 v[100:101], v[100:101], v[104:105]
    v_pk_add_f32 v[102:103], v[102:103], v[106:107]
    v_pk_add_f32 v[92:93], v[92:93], v[100:101]
    v_pk_add_f32 v[94:95], v[94:95], v[102:103]
    v_bfi_b32 v92, s31, v10, v92
    v_bfi_b32 v93, s31, v10, v93
    v_bfi_b32 v94, s31, v10, v94
    v_bfi_b32 v95, s31, v10, v95
    global_store_dwordx4 v33, v[92:95], s[52:53] sc1
    s_mov_b64 exec, -1
    s_cmp_lt_u32 s14, 10
    s_cbranch_scc0 L_u
    s_barrier
    s_waitcnt vmcnt(1)
    s_barrier
    s_lshl_b32 s47, s3, 6
    s_add_u32 s47, s47, s61
    s_mul_i32 s46, s47, 256
    s_add_u32 s46, s46, 1441792
    s_add_u32 s52, s24, s46
    s_addc_u32 s53, s25, 0
    s_barrier
    s_mov_b32 exec_hi, 0
    ds_read_b128 v[92:95], v38 offset:4096
    ds_read_b128 v[96:99], v38 offset:4352
    ds_read_b128 v[100:103], v38 offset:4608
    ds_read_b128 v[104:107], v38 offset:4864
    s_waitcnt lgkmcnt(2)
    v_pk_add_f32 v[92:93], v[92:93], v[96:97]
    v_pk_add_f32 v[94:95], v[94:95], v[98:99]
    s_waitcnt lgkmcnt(0)
    v_pk_add_f32 v[100:101], v[100:101], v[104:105]
    v_pk_add_f32 v[102:103], v[102:103], v[106:107]
    v_pk_add_f32 v[92:93], v[92:93], v[100:101]
    v_pk_add_f32 v[94:95], v[94:95], v[102:103]
    v_bfi_b32 v92, s31, v10, v92
    v_bfi_b32 v93, s31, v10, v93
    v_bfi_b32 v94, s31, v10, v94
    v_bfi_b32 v95, s31, v10, v95
    global_store_dwordx4 v33, v[92:95], s[52:53] sc1
    s_mov_b64 exec, -1
    s_branch L_exit
L_u:
    v_mov_b32 v54, 0
    v_mov_b32 v16, 0
    v_mov_b32 v55, 0
    v_mov_b32 v17, 0
    v_mov_b32 v56, 0
    v_mov_b32 v18, 0
    v_mov_b32 v57, 0
    v_mov_b32 v19, 0
    v_mov_b32 v58, 0
    v_mov_b32 v20, 0
    v_mov_b32 v59, 0
    v_mov_b32 v21, 0
    v_mov_b32 v22, 0x3f803f80
    s_mul_i32 s47, s3, 192
    s_add_u32 s47, s47, s15
    s_mul_i32 s46, s47, 128
    s_add_u32 s46, s46, 917504
    s_add_u32 s40, s24, s46
    s_addc_u32 s41, s25, 0
    s_add_u32 s52, s40, 2097152
    s_addc_u32 s53, s41, 0
    s_mul_i32 s46, s47, 128
    s_add_u32 s46, s46, 720896
    s_add_u32 s38, s24, s46
    s_addc_u32 s39, s25, 0
    s_add_u32 s42, s38, 2097152
    s_addc_u32 s43, s39, 0
    s_waitcnt vmcnt(15)
    v_perm_b32 v176, v116, v112, s44
    v_perm_b32 v177, v116, v112, s45
    v_perm_b32 v178, v117, v113, s44
    v_perm_b32 v179, v117, v113, s45
    v_perm_b32 v180, v118, v114, s44
    v_perm_b32 v181, v118, v114, s45
    v_dot2c_f32_bf16 v16, v176, v22
    v_dot2c_f32_bf16 v17, v177, v22
    v_dot2c_f32_bf16 v18, v178, v22
    v_dot2c_f32_bf16 v19, v179, v22
    v_dot2c_f32_bf16 v20, v180, v22
    v_dot2c_f32_bf16 v21, v181, v22
    s_waitcnt vmcnt(13)
    v_perm_b32 v182, v124, v120, s44
    v_perm_b32 v183, v124, v120, s45
    v_perm_b32 v184, v125, v121, s44
    v_perm_b32 v185, v125, v121, s45
    v_perm_b32 v186, v126, v122, s44
    v_perm_b32 v187, v126, v122, s45
    v_dot2c_f32_bf16 v16, v182, v22
    v_dot2c_f32_bf16 v17, v183, v22
    v_dot2c_f32_bf16 v18, v184, v22
    v_dot2c_f32_bf16 v19, v185, v22
    v_dot2c_f32_bf16 v20, v186, v22
    v_dot2c_f32_bf16 v21, v187, v22
    s_waitcnt vmcnt(11)
    v_perm_b32 v188, v132, v128, s44
    v_perm_b32 v189, v132, v128, s45
    v_perm_b32 v190, v133, v129, s44
    v_perm_b32 v191, v133, v129, s45
    v_perm_b32 v192, v134, v130, s44
    v_perm_b32 v193, v134, v130, s45
    v_dot2c_f32_bf16 v16, v188, v22
    v_dot2c_f32_bf16 v17, v189, v22
    v_dot2c_f32_bf16 v18, v190, v22
    v_dot2c_f32_bf16 v19, v191, v22
    v_dot2c_f32_bf16 v20, v192, v22
    v_dot2c_f32_bf16 v21, v193, v22
    s_waitcnt vmcnt(9)
    v_perm_b32 v194, v140, v136, s44
    v_perm_b32 v195, v140, v136, s45
    v_perm_b32 v196, v141, v137, s44
    v_perm_b32 v197, v141, v137, s45
    v_perm_b32 v198, v142, v138, s44
    v_perm_b32 v199, v142, v138, s45
    v_dot2c_f32_bf16 v16, v194, v22
    v_dot2c_f32_bf16 v17, v195, v22
    v_dot2c_f32_bf16 v18, v196, v22
    v_dot2c_f32_bf16 v19, v197, v22
    v_dot2c_f32_bf16 v20, v198, v22
    v_dot2c_f32_bf16 v21, v199, v22
    s_waitcnt vmcnt(7)
    global_load_dwordx4 v[72:75], v26, s[34:35] offset:-2560 sc1
    global_load_dwordx4 v[76:79], v26, s[34:35] offset:0 sc1
    global_load_dwordx4 v[80:83], v26, s[34:35] offset:2560 sc1
    v_perm_b32 v200, v148, v144, s44
    v_perm_b32 v201, v148, v144, s45
    v_perm_b32 v202, v149, v145, s44
    v_perm_b32 v203, v149, v145, s45
    v_perm_b32 v204, v150, v146, s44
    v_perm_b32 v205, v150, v146, s45
    v_dot2c_f32_bf16 v16, v200, v22
    v_dot2c_f32_bf16 v17, v201, v22
    v_dot2c_f32_bf16 v18, v202, v22
    v_dot2c_f32_bf16 v19, v203, v22
    v_dot2c_f32_bf16 v20, v204, v22
    v_dot2c_f32_bf16 v21, v205, v22
    s_waitcnt vmcnt(8)
    v_perm_b32 v206, v156, v152, s44
    v_perm_b32 v207, v156, v152, s45
    v_perm_b32 v208, v157, v153, s44
    v_perm_b32 v209, v157, v153, s45
    v_perm_b32 v210, v158, v154, s44
    v_perm_b32 v211, v158, v154, s45
    v_dot2c_f32_bf16 v16, v206, v22
    v_dot2c_f32_bf16 v17, v207, v22
    v_dot2c_f32_bf16 v18, v208, v22
    v_dot2c_f32_bf16 v19, v209, v22
    v_dot2c_f32_bf16 v20, v210, v22
    v_dot2c_f32_bf16 v21, v211, v22
    s_waitcnt vmcnt(6)
    v_perm_b32 v212, v164, v160, s44
    v_perm_b32 v213, v164, v160, s45
    v_perm_b32 v214, v165, v161, s44
    v_perm_b32 v215, v165, v161, s45
    v_perm_b32 v216, v166, v162, s44
    v_perm_b32 v217, v166, v162, s45
    v_dot2c_f32_bf16 v16, v212, v22
    v_dot2c_f32_bf16 v17, v213, v22
    v_dot2c_f32_bf16 v18, v214, v22
    v_dot2c_f32_bf16 v19, v215, v22
    v_dot2c_f32_bf16 v20, v216, v22
    v_dot2c_f32_bf16 v21, v217, v22
    s_waitcnt vmcnt(4)
    global_load_dwordx4 v[84:87], v26, s[34:35] offset:-2560 sc1
    global_load_dwordx4 v[88:91], v26, s[34:35] offset:0 sc1
    global_load_dwordx4 v[92:95], v26, s[34:35] offset:2560 sc1
    v_perm_b32 v218, v172, v168, s44
    v_perm_b32 v219, v172, v168, s45
    v_perm_b32 v220, v173, v169, s44
    v_perm_b32 v221, v173, v169, s45
    v_perm_b32 v222, v174, v170, s44
    v_perm_b32 v223, v174, v170, s45
    v_dot2c_f32_bf16 v16, v218, v22
    v_dot2c_f32_bf16 v17, v219, v22
    v_dot2c_f32_bf16 v18, v220, v22
    v_dot2c_f32_bf16 v19, v221, v22
    v_dot2c_f32_bf16 v20, v222, v22
    v_dot2c_f32_bf16 v21, v223, v22
    s_nop 0
    v_permlane32_swap_b32 v16, v19
    v_permlane32_swap_b32 v17, v20
    v_permlane32_swap_b32 v18, v21
    v_add_f32 v16, v16, v19
    v_add_f32 v17, v17, v20
    v_add_f32 v18, v18, v21
    v_bfi_b32 v16, s31, v10, v16
    v_bfi_b32 v17, s31, v10, v17
    v_bfi_b32 v18, s31, v10, v18
    global_store_dwordx3 v35, v[16:18], s[40:41]
    global_load_dwordx4 v[96:99], v26, s[34:35] offset:-2560 sc1
    global_load_dwordx4 v[100:103], v26, s[34:35] offset:0 sc1
    global_load_dwordx4 v[104:107], v26, s[34:35] offset:2560 sc1
    s_mov_b32 s50, 0
L_hpoll:
    s_waitcnt vmcnt(8)
    v_xor_b32 v72, v10, v72
    v_xor_b32 v73, v10, v73
    v_xor_b32 v74, v10, v74
    v_xor_b32 v75, v10, v75
    v_or3_b32 v60, v72, v73, v74
    s_waitcnt vmcnt(7)
    v_xor_b32 v76, v10, v76
    v_xor_b32 v77, v10, v77
    v_xor_b32 v78, v10, v78
    v_xor_b32 v79, v10, v79
    v_or3_b32 v60, v60, v75, v76
    v_or3_b32 v60, v60, v77, v78
    s_waitcnt vmcnt(6)
    v_xor_b32 v80, v10, v80
    v_xor_b32 v81, v10, v81
    v_xor_b32 v82, v10, v82
    v_xor_b32 v83, v10, v83
    v_or3_b32 v60, v60, v79, v80
    v_or3_b32 v60, v60, v81, v82
    v_bitop3_b32 v60, v60, v83, s31 bitop3:168
    v_cmp_ne_u32 vcc, 0, v60
    s_cbranch_vccz L_hpoll_k0
    global_load_dwordx4 v[72:75], v26, s[34:35] offset:-2560 sc1
    global_load_dwordx4 v[76:79], v26, s[34:35] offset:0 sc1
    global_load_dwordx4 v[80:83], v26, s[34:35] offset:2560 sc1
    s_waitcnt vmcnt(8)
    v_xor_b32 v84, v10, v84
    v_xor_b32 v85, v10, v85
    v_xor_b32 v86, v10, v86
    v_xor_b32 v87, v10, v87
    v_or3_b32 v60, v84, v85, v86
    s_waitcnt vmcnt(7)
    v_xor_b32 v88, v10, v88
    v_xor_b32 v89, v10, v89
    v_xor_b32 v90, v10, v90
    v_xor_b32 v91, v10, v91
    v_or3_b32 v60, v60, v87, v88
    v_or3_b32 v60, v60, v89, v90
    s_waitcnt vmcnt(6)
    v_xor_b32 v92, v10, v92
    v_xor_b32 v93, v10, v93
    v_xor_b32 v94, v10, v94
    v_xor_b32 v95, v10, v95
    v_or3_b32 v60, v60, v91, v92
    v_or3_b32 v60, v60, v93, v94
    v_bitop3_b32 v60, v60, v95, s31 bitop3:168
    v_cmp_ne_u32 vcc, 0, v60
    s_cbranch_vccz L_hpoll_k1
    global_load_dwordx4 v[84:87], v26, s[34:35] offset:-2560 sc1
    global_load_dwordx4 v[88:91], v26, s[34:35] offset:0 sc1
    global_load_dwordx4 v[92:95], v26, s[34:35] offset:2560 sc1
    s_waitcnt vmcnt(8)
    v_xor_b32 v96, v10, v96
    v_xor_b32 v97, v10, v97
    v_xor_b32 v98, v10, v98
    v_xor_b32 v99, v10, v99
    v_or3_b32 v60, v96, v97, v98
    s_waitcnt vmcnt(7)
    v_xor_b32 v100, v10, v100
    v_xor_b32 v101, v10, v101
    v_xor_b32 v102, v10, v102
    v_xor_b32 v103, v10, v103
    v_or3_b32 v60, v60, v99, v100
    v_or3_b32 v60, v60, v101, v102
    s_waitcnt vmcnt(6)
    v_xor_b32 v104, v10, v104
    v_xor_b32 v105, v10, v105
    v_xor_b32 v106, v10, v106
    v_xor_b32 v107, v10, v107
    v_or3_b32 v60, v60, v103, v104
    v_or3_b32 v60, v60, v105, v106
    v_bitop3_b32 v60, v60, v107, s31 bitop3:168
    v_cmp_ne_u32 vcc, 0, v60
    s_cbranch_vccz L_hpoll_k2
    global_load_dwordx4 v[96:99], v26, s[34:35] offset:-2560 sc1
    global_load_dwordx4 v[100:103], v26, s[34:35] offset:0 sc1
    global_load_dwordx4 v[104:107], v26, s[34:35] offset:2560 sc1
    s_add_u32 s50, s50, 1
    s_cmp_gt_u32 s50, 100000
    s_cbranch_scc1 L_exit
    s_branch L_hpoll
L_hpoll_k2:
    v_pk_add_f32 v[68:69], v[96:97], v[100:101]
    v_pk_add_f32 v[70:71], v[98:99], v[102:103]
    v_pk_add_f32 v[68:69], v[68:69], v[104:105]
    v_pk_add_f32 v[70:71], v[70:71], v[106:107]
    s_branch L_hpoll_ok
L_hpoll_k1:
    v_pk_add_f32 v[68:69], v[84:85], v[88:89]
    v_pk_add_f32 v[70:71], v[86:87], v[90:91]
    v_pk_add_f32 v[68:69], v[68:69], v[92:93]
    v_pk_add_f32 v[70:71], v[70:71], v[94:95]
    s_branch L_hpoll_ok
L_hpoll_k0:
    v_pk_add_f32 v[68:69], v[72:73], v[76:77]
    v_pk_add_f32 v[70:71], v[74:75], v[78:79]
    v_pk_add_f32 v[68:69], v[68:69], v[80:81]
    v_pk_add_f32 v[70:71], v[70:71], v[82:83]
L_hpoll_ok:
    s_nop 1
    v_permlane32_swap_b32 v68, v70
    v_permlane32_swap_b32 v69, v71
    v_add_f32 v68, v68, v70
    v_add_f32 v69, v69, v71
    s_nop 1
    v_permlane16_swap_b32 v68, v69
    v_add_f32 v68, v68, v69
    s_nop 1
    v_add_f32_dpp v68, v68, v68 row_ror:8 row_mask:0xf bank_mask:0xf
    v_cvt_pk_bf16_f32 v68, v68, v68
    v_and_b32 v68, s64, v68
    v_add_f32 v68, v68, v15
    v_mov_b32 v69, v68
    v_cvt_pk_bf16_f32 v66, v68, v68
    v_mov_b32 v60, 0
    v_mov_b32 v61, 0
    v_permlane16_swap_b32 v68, v69
    v_cvt_pk_bf16_f32 v70, v68, v69
    s_nop 1
    v_dot2c_f32_bf16_dpp v54, v70, v176 row_newbcast:0 row_mask:0xf bank_mask:0xf
    v_dot2c_f32_bf16_dpp v55, v70, v177 row_newbcast:0 row_mask:0xf bank_mask:0xf
    v_dot2c_f32_bf16_dpp v56, v70, v178 row_newbcast:0 row_mask:0xf bank_mask:0xf
    v_dot2c_f32_bf16_dpp v57, v70, v179 row_newbcast:0 row_mask:0xf bank_mask:0xf
    v_dot2c_f32_bf16_dpp v58, v70, v180 row_newbcast:0 row_mask:0xf bank_mask:0xf
    v_dot2c_f32_bf16_dpp v59, v70, v181 row_newbcast:0 row_mask:0xf bank_mask:0xf
    v_dot2c_f32_bf16 v60, v70, v22
    v_dot2c_f32_bf16 v61, v70, v70
    v_dot2c_f32_bf16_dpp v54, v70, v182 row_newbcast:1 row_mask:0xf bank_mask:0xf
    v_dot2c_f32_bf16_dpp v55, v70, v183 row_newbcast:1 row_mask:0xf bank_mask:0xf
    v_dot2c_f32_bf16_dpp v56, v70, v184 row_newbcast:1 row_mask:0xf bank_mask:0xf
    v_dot2c_f32_bf16_dpp v57, v70, v185 row_newbcast:1 row_mask:0xf bank_mask:0xf
    v_dot2c_f32_bf16_dpp v58, v70, v186 row_newbcast:1 row_mask:0xf bank_mask:0xf
    v_dot2c_f32_bf16_dpp v59, v70, v187 row_newbcast:1 row_mask:0xf bank_mask:0xf
    v_add_f32_dpp v60, v60, v60 quad_perm:[1,0,3,2] row_mask:0xf bank_mask:0xf
    v_add_f32_dpp v61, v61, v61 quad_perm:[1,0,3,2] row_mask:0xf bank_mask:0xf
    v_dot2c_f32_bf16_dpp v54, v70, v188 row_newbcast:2 row_mask:0xf bank_mask:0xf
    v_dot2c_f32_bf16_dpp v55, v70, v189 row_newbcast:2 row_mask:0xf bank_mask:0xf
    v_dot2c_f32_bf16_dpp v56, v70, v190 row_newbcast:2 row_mask:0xf bank_mask:0xf
    v_dot2c_f32_bf16_dpp v57, v70, v191 row_newbcast:2 row_mask:0xf bank_mask:0xf
    v_dot2c_f32_bf16_dpp v58, v70, v192 row_newbcast:2 row_mask:0xf bank_mask:0xf
    v_dot2c_f32_bf16_dpp v59, v70, v193 row_newbcast:2 row_mask:0xf bank_mask:0xf
    v_add_f32_dpp v60, v60, v60 quad_perm:[2,3,0,1] row_mask:0xf bank_mask:0xf
    v_add_f32_dpp v61, v61, v61 quad_perm:[2,3,0,1] row_mask:0xf bank_mask:0xf
    v_dot2c_f32_bf16_dpp v54, v70, v194 row_newbcast:3 row_mask:0xf bank_mask:0xf
    v_dot2c_f32_bf16_dpp v55, v70, v195 row_newbcast:3 row_mask:0xf bank_mask:0xf
    v_dot2c_f32_bf16_dpp v56, v70, v196 row_newbcast:3 row_mask:0xf bank_mask:0xf
    v_dot2c_f32_bf16_dpp v57, v70, v197 row_newbcast:3 row_mask:0xf bank_mask:0xf
    v_dot2c_f32_bf16_dpp v58, v70, v198 row_newbcast:3 row_mask:0xf bank_mask:0xf
    v_dot2c_f32_bf16_dpp v59, v70, v199 row_newbcast:3 row_mask:0xf bank_mask:0xf
    v_add_f32_dpp v60, v60, v60 row_half_mirror row_mask:0xf bank_mask:0xf
    v_add_f32_dpp v61, v61, v61 row_half_mirror row_mask:0xf bank_mask:0xf
    v_dot2c_f32_bf16_dpp v54, v70, v200 row_newbcast:4 row_mask:0xf bank_mask:0xf
    v_dot2c_f32_bf16_dpp v55, v70, v201 row_newbcast:4 row_mask:0xf bank_mask:0xf
    v_dot2c_f32_bf16_dpp v56, v70, v202 row_newbcast:4 row_mask:0xf bank_mask:0xf
    v_dot2c_f32_bf16_dpp v57, v70, v203 row_newbcast:4 row_mask:0xf bank_mask:0xf
    v_dot2c_f32_bf16_dpp v58, v70, v204 row_newbcast:4 row_mask:0xf bank_mask:0xf
    v_dot2c_f32_bf16_dpp v59, v70, v205 row_newbcast:4 row_mask:0xf bank_mask:0xf
    v_permlane32_swap_b32 v60, v61
    v_dot2c_f32_bf16_dpp v54, v70, v206 row_newbcast:5 row_mask:0xf bank_mask:0xf
    v_dot2c_f32_bf16_dpp v55, v70, v207 row_newbcast:5 row_mask:0xf bank_mask:0xf
    v_dot2c_f32_bf16_dpp v56, v70, v208 row_newbcast:5 row_mask:0xf bank_mask:0xf
    v_dot2c_f32_bf16_dpp v57, v70, v209 row_newbcast:5 row_mask:0xf bank_mask:0xf
    v_dot2c_f32_bf16_dpp v58, v70, v210 row_newbcast:5 row_mask:0xf bank_mask:0xf
    v_dot2c_f32_bf16_dpp v59, v70, v211 row_newbcast:5 row_mask:0xf bank_mask:0xf
    v_add_f32 v60, v60, v61
    v_bfi_b32 v62, s31, 0, v60
    v_dot2c_f32_bf16_dpp v54, v70, v212 row_newbcast:6 row_mask:0xf bank_mask:0xf
    v_dot2c_f32_bf16_dpp v55, v70, v213 row_newbcast:6 row_mask:0xf bank_mask:0xf
    v_dot2c_f32_bf16_dpp v56, v70, v214 row_newbcast:6 row_mask:0xf bank_mask:0xf
    v_dot2c_f32_bf16_dpp v57, v70, v215 row_newbcast:6 row_mask:0xf bank_mask:0xf
    v_dot2c_f32_bf16_dpp v58, v70, v216 row_newbcast:6 row_mask:0xf bank_mask:0xf
    v_dot2c_f32_bf16_dpp v59, v70, v217 row_newbcast:6 row_mask:0xf bank_mask:0xf
    v_sub_f32 v63, v60, v62
    v_or_b32 v62, v62, v10
    v_bfi_b32 v63, s31, v10, v63
    s_mov_b32 exec_lo, 0xff
    s_mov_b32 exec_hi, 0xff
    global_store_dwordx2 v36, v[62:63], s[38:39]
    s_mov_b64 exec, -1
    v_dot2c_f32_bf16_dpp v54, v70, v218 row_newbcast:7 row_mask:0xf bank_mask:0xf
    v_dot2c_f32_bf16_dpp v55, v70, v219 row_newbcast:7 row_mask:0xf bank_mask:0xf
    v_dot2c_f32_bf16_dpp v56, v70, v220 row_newbcast:7 row_mask:0xf bank_mask:0xf
    v_dot2c_f32_bf16_dpp v57, v70, v221 row_newbcast:7 row_mask:0xf bank_mask:0xf
    v_dot2c_f32_bf16_dpp v58, v70, v222 row_newbcast:7 row_mask:0xf bank_mask:0xf
    v_dot2c_f32_bf16_dpp v59, v70, v223 row_newbcast:7 row_mask:0xf bank_mask:0xf
    s_nop 0
    v_permlane32_swap_b32 v54, v57
    v_permlane32_swap_b32 v55, v58
    v_permlane32_swap_b32 v56, v59
    v_add_f32 v54, v54, v57
    v_add_f32 v55, v55, v58
    v_add_f32 v56, v56, v59
    v_bfi_b32 v54, s31, v10, v54
    v_bfi_b32 v55, s31, v10, v55
    v_bfi_b32 v56, s31, v10, v56
    global_store_dwordx3 v35, v[54:56], s[38:39]
    s_cmp_eq_u32 s67, 0
    s_cbranch_scc1 Lfb_8
    global_store_dwordx3 v35, v[54:56], s[42:43] sc1
    global_store_dwordx3 v35, v[16:18], s[52:53] sc1
    s_mov_b32 exec_lo, 0xff
    s_mov_b32 exec_hi, 0xff
    global_store_dwordx2 v36, v[62:63], s[42:43] sc1
    s_mov_b64 exec, -1
Lfb_8:
    s_and_b32 s47, s15, 7
    s_cmp_eq_u32 s47, s3
    s_cbranch_scc0 L_exit
    v_and_b32 v66, s64, v66
    v_lshrrev_b32 v12, 1, v30
    s_lshl_b32 s47, s15, 6
    s_add_u32 s42, s20, s47
    s_addc_u32 s43, s21, 0
    global_load_dwordx4 v[112:115], v26, s[54:55] sc1
    global_load_dwordx4 v[116:119], v26, s[54:55] sc1
    global_load_dwordx4 v[120:123], v26, s[54:55] sc1
    global_load_dwordx4 v[124:127], v26, s[54:55] sc1
    s_mov_b32 s50, 0
L_zgat:
    s_waitcnt vmcnt(3)
    v_xor_b32 v112, v10, v112
    v_xor_b32 v113, v10, v113
    v_xor_b32 v114, v10, v114
    v_xor_b32 v115, v10, v115
    v_or3_b32 v60, v112, v113, v114
    v_bitop3_b32 v60, v60, v115, s31 bitop3:168
    v_cmp_ne_u32 vcc, 0, v60
    s_cbranch_vccz L_zgat_k0
    global_load_dwordx4 v[112:115], v26, s[54:55] sc1
    s_waitcnt vmcnt(3)
    v_xor_b32 v116, v10, v116
    v_xor_b32 v117, v10, v117
    v_xor_b32 v118, v10, v118
    v_xor_b32 v119, v10, v119
    v_or3_b32 v60, v116, v117, v118
    v_bitop3_b32 v60, v60, v119, s31 bitop3:168
    v_cmp_ne_u32 vcc, 0, v60
    s_cbranch_vccz L_zgat_k1
    global_load_dwordx4 v[116:119], v26, s[54:55] sc1
    s_waitcnt vmcnt(3)
    v_xor_b32 v120, v10, v120
    v_xor_b32 v121, v10, v121
    v_xor_b32 v122, v10, v122
    v_xor_b32 v123, v10, v123
    v_or3_b32 v60, v120, v121, v122
    v_bitop3_b32 v60, v60, v123, s31 bitop3:168
    v_cmp_ne_u32 vcc, 0, v60
    s_cbranch_vccz L_zgat_k2
    global_load_dwordx4 v[120:123], v26, s[54:55] sc1
    s_waitcnt vmcnt(3)
    v_xor_b32 v124, v10, v124
    v_xor_b32 v125, v10, v125
    v_xor_b32 v126, v10, v126
    v_xor_b32 v127, v10, v127
    v_or3_b32 v60, v124, v125, v126
    v_bitop3_b32 v60, v60, v127, s31 bitop3:168
    v_cmp_ne_u32 vcc, 0, v60
    s_cbranch_vccz L_zgat_k3
    global_load_dwordx4 v[124:127], v26, s[54:55] sc1
    s_add_u32 s50, s50, 1
    s_cmp_gt_u32 s50, 100000
    s_cbranch_scc1 L_exit
    s_branch L_zgat
L_zgat_k3:
    v_pk_mov_b32 v[50:51], v[124:125], v[124:125] op_sel:[0,1]
    v_pk_mov_b32 v[52:53], v[126:127], v[126:127] op_sel:[0,1]
    s_branch L_zgat_ok
L_zgat_k2:
    v_pk_mov_b32 v[50:51], v[120:121], v[120:121] op_sel:[0,1]
    v_pk_mov_b32 v[52:53], v[122:123], v[122:123] op_sel:[0,1]
    s_branch L_zgat_ok
L_zgat_k1:
    v_pk_mov_b32 v[50:51], v[116:117], v[116:117] op_sel:[0,1]
    v_pk_mov_b32 v[52:53], v[118:119], v[118:119] op_sel:[0,1]
    s_branch L_zgat_ok
L_zgat_k0:
    v_pk_mov_b32 v[50:51], v[112:113], v[112:113] op_sel:[0,1]
    v_pk_mov_b32 v[52:53], v[114:115], v[114:115] op_sel:[0,1]
L_zgat_ok:
    s_nop 1
    v_permlane32_swap_b32 v50, v52
    v_permlane32_swap_b32 v51, v53
    v_add_f32 v50, v50, v52
    v_add_f32 v51, v51, v53
    s_nop 1
    v_permlane16_swap_b32 v50, v51
    v_add_f32 v50, v50, v51
    s_nop 1
    v_add_f32_dpp v50, v50, v50 row_ror:8 row_mask:0xf bank_mask:0xf
    v_cvt_pk_bf16_f32 v50, v50, v50
    v_and_b32 v50, s64, v50
    v_add_f32 v50, v50, v66
    v_cvt_pk_bf16_f32 v50, v50, v50
    s_mov_b32 exec_lo, 0x00ff00ff
    s_mov_b32 exec_hi, 0x00ff00ff
    global_store_short v12, v50, s[42:43]
    s_mov_b64 exec, -1
    s_cmp_eq_u32 s15, 0
    s_cbranch_scc0 L_exit
    v_mov_b32 v11, 0
    s_mov_b64 exec, 1
    global_store_dword v11, v10, s[24:25]
    s_mov_b64 exec, -1
L_exit:
L_end:
s_endpgm
.section .rodata,"a"
.p2align 6
.amdhsa_kernel sequential_preLN__sliding_block_cached__dense_activation_silu__decode_kernel
  .amdhsa_next_free_vgpr 240
  .amdhsa_next_free_sgpr 72
  .amdhsa_accum_offset 240
  .amdhsa_group_segment_fixed_size 0
  .amdhsa_kernarg_size 88
  .amdhsa_user_sgpr_count 2
  .amdhsa_user_sgpr_kernarg_segment_ptr 1
  .amdhsa_system_sgpr_workgroup_id_x 1
  .amdhsa_float_denorm_mode_32 3
.end_amdhsa_kernel
```
